```python
import torch

def _softmax(x, axis=-1):
    return torch.softmax(x, dim=axis)
def _gelu(x):
    return torch.nn.functional.gelu(x, approximate="tanh")
def _silu(x):
    return torch.nn.functional.silu(x)
def _sigmoid(x):
    return torch.sigmoid(x)
def _layernorm(x, axis=-1, eps=1e-5):
    m = x.mean(dim=axis, keepdim=True)
    v = x.var(dim=axis, keepdim=True, unbiased=False)
    return (x - m) / torch.sqrt(v + eps)
def _scatter_add(tgt, idx, src, axis=0):
    return tgt.clone().index_add_(axis, idx, src)
def _segment_sum(src, seg, n):
    out = torch.zeros((n,) + src.shape[1:], dtype=src.dtype)
    return out.index_add_(0, seg, src)
def _pad(x, pw):
    flat = tuple(v for pair in reversed(pw) for v in pair)
    return torch.nn.functional.pad(x, flat)

kernel_name = 'gated_mix__mha_block__dense_activation_mish__prompt'

def setup_inputs():

    _w = (lambda a: (lambda t: t.to(torch.bfloat16) if t.is_floating_point() else t)(torch.as_tensor(a)))
    def _A_setup():
        B, S, D, H = 1, 2048, 512, 32
        return {
            "x": _w((lambda *s: torch.randn(*s, dtype=torch.bfloat16) * 0.05)(B, S, D)),
            "wqkv": _w((lambda *s: torch.randn(*s, dtype=torch.bfloat16) * 0.8)(D, 3 * D)),
            "wo": _w((lambda *s: torch.randn(*s, dtype=torch.bfloat16) * 0.05)(D, D)),
        }
    _A_in = _A_setup()

    def _B_setup():
        B, S, D, F = 1, 2048, 512, 1376
        return {
            "x": _w((lambda *s: torch.randn(*s, dtype=torch.bfloat16) * 0.05)(B, S, D)),
            "w1": _w((lambda *s: torch.randn(*s, dtype=torch.bfloat16) * 12.8)(D, F) * (D ** -0.5)),
            "b1": _w((lambda *s: torch.randn(*s, dtype=torch.bfloat16) * 0.2)(F)),
            "w2": _w((lambda *s: torch.randn(*s, dtype=torch.bfloat16) * 0.1)(F, D) * (F ** -0.5)),
        }
    _B_in = _B_setup()

    return {
        "A_x": _A_in["x"],
        "A_wqkv": _A_in["wqkv"],
        "A_wo": _A_in["wo"],
        "B_x": _B_in["x"],
        "B_w1": _B_in["w1"],
        "B_b1": _B_in["b1"],
        "B_w2": _B_in["w2"],
        "gate_w": _w((lambda *s: torch.randn(*s, dtype=torch.bfloat16) * 0.05)(512) * 16.0),
    }

def reference(A_x, A_wqkv, A_wo, B_x, B_w1, B_b1, B_w2, gate_w):
    def _A_ref(x, wqkv, wo):
        B, S, D = x.shape
        H = 32
        Dh = D // H
        qkv = (lambda x, *d: x.permute(*d))((x @ wqkv).reshape(B, S, 3, H, Dh), 2, 0, 3, 1, 4)
        q, k, v = qkv[0], qkv[1], qkv[2]
        scores = torch.einsum("bhqd,bhkd->bhqk", q, k) * (Dh ** -0.5)
        p = _softmax(scores, axis=-1)
        o = torch.einsum("bhqk,bhkd->bhqd", p, v)
        return (lambda x, *d: x.permute(*d))(o, 0, 2, 1, 3).reshape(B, S, D) @ wo

    def _B_ref(x, w1, b1, w2):
        h = torch.einsum("bsd,df->bsf", x, w1) + b1
        sp = torch.log1p(torch.exp(-torch.abs(h))) + torch.where(h > 0, h, torch.zeros_like(h))
        act = h * torch.tanh(sp)
        return torch.einsum("bsf,fd->bsd", act, w2)

    x = A_x
    g = _sigmoid((x * gate_w).sum(-1, keepdims=True))
    a = _A_ref(x, A_wqkv, A_wo)
    b = _B_ref(x, B_w1, B_b1, B_w2)
    return g * a + (1 - g) * b
```

```asm
; @launch kernel=gm_k1_kernel grid=(256,1,1) block=(768,1,1) lds=122880
; @launch kernel=gm_k2_kernel grid=(256,1,1) block=(768,1,1) lds=139520
.amdgcn_target "amdgcn-amd-amdhsa--gfx950"
.text
.globl gm_k1_kernel
.p2align 8
.type gm_k1_kernel,@function
gm_k1_kernel:
    s_cmp_ge_u32 s2, 256
    s_cbranch_scc1 K1_END2
    s_load_dwordx16 s[36:51], s[0:1], 0
    s_load_dwordx2 s[52:53], s[0:1], 80
    s_and_b32 s3, s2, 15
    s_lshr_b32 s4, s2, 4
    v_lshrrev_b32 v1, 6, v0
    s_nop 0
    v_readfirstlane_b32 s5, v1
    v_and_b32 v1, 63, v0
    v_and_b32 v2, 31, v0
    v_bfe_u32 v3, v0, 5, 1
    s_and_b32 s6, s5, 3
    s_lshr_b32 s7, s5, 2
    v_lshrrev_b32 v18, 3, v1
    v_and_b32 v19, 7, v1
    v_lshrrev_b32 v20, 1, v18
    s_lshl_b32 s60, s3, 7
    s_lshl_b32 s61, s5, 3
    s_add_u32 s60, s60, s61
    v_add_u32 v21, s60, v18
    v_lshlrev_b32 v21, 10, v21
    s_and_b32 s61, s5, 1
    s_lshl_b32 s61, s61, 2
    v_xor_b32 v22, s61, v20
    v_xor_b32 v22, v22, v19
    v_lshl_add_u32 v4, v22, 4, v21
    v_add_u32 v5, 98304, v4
    s_lshl_b32 s60, s5, 6
    s_mul_i32 s61, s4, 192
    v_add_u32 v18, s60, v1
    v_mul_u32_u24 v19, 43691, v18
    v_lshrrev_b32 v19, 19, v19
    v_mul_u32_u24 v20, 12, v19
    v_sub_u32 v20, v18, v20
    v_lshlrev_b32 v20, 4, v20
    v_add_u32 v20, s61, v20
    v_mul_u32_u24 v21, 3072, v19
    v_add_u32 v6, v21, v20
    v_mul_u32_u24 v21, 2752, v19
    v_add_u32 v7, v21, v20
    s_lshl_b32 s67, s5, 10
    s_waitcnt lgkmcnt(0)
    s_mov_b32 s8, s36
    s_and_b32 s9, s37, 0xffff
    s_mov_b32 s10, 2097152
    s_mov_b32 s11, 0x00020000
    s_mov_b32 s12, s38
    s_and_b32 s13, s39, 0xffff
    s_mov_b32 s14, 1572864
    s_mov_b32 s15, 0x00020000
    s_mov_b32 s16, s44
    s_and_b32 s17, s45, 0xffff
    s_mov_b32 s18, 1409024
    s_mov_b32 s19, 0x00020000
    s_mov_b32 s60, 0
    s_mov_b32 s61, 0
    s_mov_b32 s62, 0
    s_add_u32 m0, s67, 0
    s_nop 0
    buffer_load_dwordx4 v4, s[8:11], s62 offen lds
    s_add_u32 m0, s67, 49152
    s_nop 0
    buffer_load_dwordx4 v6, s[12:15], s60 offen lds
    s_add_u32 m0, s67, 86016
    s_nop 0
    buffer_load_dwordx4 v7, s[16:19], s61 offen lds
    s_cmp_ge_u32 s5, 4
    s_cbranch_scc1 K1_NOX2_1
    s_add_u32 m0, s67, 12288
    s_nop 0
    buffer_load_dwordx4 v5, s[8:11], s62 offen lds
K1_NOX2_1:
    s_mov_b32 s60, 196608
    s_mov_b32 s61, 176128
    s_mov_b32 s62, 128
    s_add_u32 m0, s67, 16384
    s_nop 0
    buffer_load_dwordx4 v4, s[8:11], s62 offen lds
    s_add_u32 m0, s67, 61440
    s_nop 0
    buffer_load_dwordx4 v6, s[12:15], s60 offen lds
    s_add_u32 m0, s67, 98304
    s_nop 0
    buffer_load_dwordx4 v7, s[16:19], s61 offen lds
    s_cmp_ge_u32 s5, 4
    s_cbranch_scc1 K1_NOX2_2
    s_add_u32 m0, s67, 28672
    s_nop 0
    buffer_load_dwordx4 v5, s[8:11], s62 offen lds
K1_NOX2_2:
    s_mov_b32 s20, s52
    s_and_b32 s21, s53, 0xffff
    s_mov_b32 s22, 268435456
    s_mov_b32 s23, 0x00020000
    s_mov_b32 s24, s46
    s_and_b32 s25, s47, 0xffff
    s_mov_b32 s26, 2752
    s_mov_b32 s27, 0x00020000
    s_mov_b32 s32, s50
    s_and_b32 s33, s51, 0xffff
    s_mov_b32 s34, 1024
    s_mov_b32 s35, 0x00020000
    s_sub_u32 s54, s2, 172
    s_mov_b32 s70, 524288
    s_cmp_lt_u32 s2, 172
    s_cselect_b32 s28, s48, s40
    s_cselect_b32 s29, s49, s41
    s_cselect_b32 s30, 1409024, s70
    s_cselect_b32 s54, s2, s54
    s_and_b32 s29, s29, 0xffff
    s_mov_b32 s31, 0x00020000
    s_lshr_b32 s55, s54, 2
    s_and_b32 s56, s54, 3
    v_lshrrev_b32 v18, 4, v0
    v_and_b32 v19, 15, v0
    v_lshlrev_b32 v18, 10, v18
    v_lshl_add_u32 v15, v19, 4, v18
    s_lshl_b32 s57, s55, 15
    s_lshl_b32 s58, s56, 8
    s_add_u32 s57, s57, s58
    s_add_u32 s58, s57, 16384
    v_lshlrev_b32 v16, 4, v1
    s_lshl_b32 s59, s2, 3
    s_lshl_b32 s60, s6, 1
    s_add_u32 s59, s59, s60
    s_lshl_b32 s68, s59, 10
    s_add_u32 s69, s68, 1024
    v_lshlrev_b32 v17, 3, v3
    s_mul_i32 s71, s4, 192
    s_lshl_b32 s60, s7, 6
    s_add_u32 s71, s71, s60
    s_lshl_b32 s60, s6, 5
    v_add_u32 v18, s60, v2
    v_lshlrev_b32 v18, 7, v18
    v_bfe_u32 v19, v2, 1, 3
    v_add_u32 v20, 0, v3
    v_xor_b32 v20, v20, v19
    v_lshl_add_u32 v8, v20, 4, v18
    v_add_u32 v20, 2, v3
    v_xor_b32 v20, v20, v19
    v_lshl_add_u32 v9, v20, 4, v18
    v_add_u32 v20, 4, v3
    v_xor_b32 v20, v20, v19
    v_lshl_add_u32 v10, v20, 4, v18
    v_add_u32 v20, 6, v3
    v_xor_b32 v20, v20, v19
    v_lshl_add_u32 v11, v20, 4, v18
    v_bfe_u32 v18, v0, 2, 2
    v_lshl_add_u32 v18, v3, 3, v18
    v_mul_u32_u24 v18, 192, v18
    v_and_b32 v19, 3, v0
    v_lshlrev_b32 v19, 3, v19
    v_bfe_u32 v20, v0, 4, 1
    v_lshl_add_u32 v19, v20, 5, v19
    v_add_u32 v18, v18, v19
    s_lshl_b32 s60, s7, 6
    v_add_u32 v18, s60, v18
    v_add_u32 v12, 49152, v18
    v_add_u32 v13, 86016, v18
    s_lshl_b32 s60, s3, 7
    s_lshl_b32 s61, s6, 5
    s_add_u32 s66, s60, s61
    v_add_u32 v14, s66, v2
    s_mov_b32 s80, 2.0
    s_mov_b32 s81, 2.0
    s_mov_b32 s82, 0x3fb8aa3b
    s_mov_b32 s83, 0x3fb8aa3b
    s_cmp_ge_u32 s5, 4
    s_cbranch_scc1 K1_W_3
    s_waitcnt vmcnt(4)
    s_branch K1_W_4
K1_W_3:
    s_waitcnt vmcnt(3)
K1_W_4:
    s_barrier
    ds_read_b128 v[60:63], v8 offset:0
    ds_read_b64_tr_b16 v[52:53], v12 offset:0
    ds_read_b64_tr_b16 v[54:55], v12 offset:768
    ds_read_b64_tr_b16 v[56:57], v13 offset:0
    ds_read_b64_tr_b16 v[58:59], v13 offset:768
    s_waitcnt lgkmcnt(0)
    v_mfma_f32_32x32x16_bf16 v[76:91], v[52:55], v[60:63], 0
    ds_read_b128 v[72:75], v9 offset:0
    ds_read_b64_tr_b16 v[64:65], v12 offset:3072
    ds_read_b64_tr_b16 v[66:67], v12 offset:3840
    ds_read_b64_tr_b16 v[68:69], v13 offset:3072
    ds_read_b64_tr_b16 v[70:71], v13 offset:3840
    v_mfma_f32_32x32x16_bf16 v[92:107], v[56:59], v[60:63], 0
    s_mov_b32 s60, 393216
    s_mov_b32 s61, 352256
    s_mov_b32 s62, 256
    s_add_u32 m0, s67, 32768
    s_nop 0
    buffer_load_dwordx4 v4, s[8:11], s62 offen lds
    s_add_u32 m0, s67, 73728
    s_nop 0
    buffer_load_dwordx4 v6, s[12:15], s60 offen lds
    s_add_u32 m0, s67, 110592
    s_nop 0
    buffer_load_dwordx4 v7, s[16:19], s61 offen lds
    s_cmp_ge_u32 s5, 4
    s_cbranch_scc1 K1_NOX2_5
    s_add_u32 m0, s67, 45056
    s_nop 0
    buffer_load_dwordx4 v5, s[8:11], s62 offen lds
K1_NOX2_5:
    s_waitcnt lgkmcnt(0)
    v_mfma_f32_32x32x16_bf16 v[76:91], v[64:67], v[72:75], v[76:91]
    ds_read_b128 v[60:63], v10 offset:0
    ds_read_b64_tr_b16 v[52:53], v12 offset:6144
    ds_read_b64_tr_b16 v[54:55], v12 offset:6912
    ds_read_b64_tr_b16 v[56:57], v13 offset:6144
    ds_read_b64_tr_b16 v[58:59], v13 offset:6912
    v_mfma_f32_32x32x16_bf16 v[92:107], v[68:71], v[72:75], v[92:107]
    s_waitcnt lgkmcnt(0)
    v_mfma_f32_32x32x16_bf16 v[76:91], v[52:55], v[60:63], v[76:91]
    ds_read_b128 v[72:75], v11 offset:0
    ds_read_b64_tr_b16 v[64:65], v12 offset:9216
    ds_read_b64_tr_b16 v[66:67], v12 offset:9984
    ds_read_b64_tr_b16 v[68:69], v13 offset:9216
    ds_read_b64_tr_b16 v[70:71], v13 offset:9984
    v_mfma_f32_32x32x16_bf16 v[92:107], v[56:59], v[60:63], v[92:107]
    s_waitcnt lgkmcnt(0)
    s_cmp_ge_u32 s5, 4
    s_cbranch_scc1 K1_W_6
    s_waitcnt vmcnt(4)
    s_branch K1_W_7
K1_W_6:
    s_waitcnt vmcnt(3)
K1_W_7:
    s_barrier
    v_mfma_f32_32x32x16_bf16 v[76:91], v[64:67], v[72:75], v[76:91]
    ds_read_b128 v[60:63], v8 offset:16384
    ds_read_b64_tr_b16 v[52:53], v12 offset:12288
    ds_read_b64_tr_b16 v[54:55], v12 offset:13056
    ds_read_b64_tr_b16 v[56:57], v13 offset:12288
    ds_read_b64_tr_b16 v[58:59], v13 offset:13056
    v_mfma_f32_32x32x16_bf16 v[92:107], v[68:71], v[72:75], v[92:107]
    s_waitcnt lgkmcnt(0)
    v_mfma_f32_32x32x16_bf16 v[76:91], v[52:55], v[60:63], v[76:91]
    ds_read_b128 v[72:75], v9 offset:16384
    ds_read_b64_tr_b16 v[64:65], v12 offset:15360
    ds_read_b64_tr_b16 v[66:67], v12 offset:16128
    ds_read_b64_tr_b16 v[68:69], v13 offset:15360
    ds_read_b64_tr_b16 v[70:71], v13 offset:16128
    v_mfma_f32_32x32x16_bf16 v[92:107], v[56:59], v[60:63], v[92:107]
    s_mov_b32 s60, 589824
    s_mov_b32 s61, 528384
    s_mov_b32 s62, 384
    s_add_u32 m0, s67, 0
    s_nop 0
    buffer_load_dwordx4 v4, s[8:11], s62 offen lds
    s_add_u32 m0, s67, 49152
    s_nop 0
    buffer_load_dwordx4 v6, s[12:15], s60 offen lds
    s_add_u32 m0, s67, 86016
    s_nop 0
    buffer_load_dwordx4 v7, s[16:19], s61 offen lds
    s_cmp_ge_u32 s5, 4
    s_cbranch_scc1 K1_NOX2_8
    s_add_u32 m0, s67, 12288
    s_nop 0
    buffer_load_dwordx4 v5, s[8:11], s62 offen lds
K1_NOX2_8:
    s_waitcnt lgkmcnt(0)
    v_mfma_f32_32x32x16_bf16 v[76:91], v[64:67], v[72:75], v[76:91]
    ds_read_b128 v[60:63], v10 offset:16384
    ds_read_b64_tr_b16 v[52:53], v12 offset:18432
    ds_read_b64_tr_b16 v[54:55], v12 offset:19200
    ds_read_b64_tr_b16 v[56:57], v13 offset:18432
    ds_read_b64_tr_b16 v[58:59], v13 offset:19200
    v_mfma_f32_32x32x16_bf16 v[92:107], v[68:71], v[72:75], v[92:107]
    s_waitcnt lgkmcnt(0)
    v_mfma_f32_32x32x16_bf16 v[76:91], v[52:55], v[60:63], v[76:91]
    ds_read_b128 v[72:75], v11 offset:16384
    ds_read_b64_tr_b16 v[64:65], v12 offset:21504
    ds_read_b64_tr_b16 v[66:67], v12 offset:22272
    ds_read_b64_tr_b16 v[68:69], v13 offset:21504
    ds_read_b64_tr_b16 v[70:71], v13 offset:22272
    v_mfma_f32_32x32x16_bf16 v[92:107], v[56:59], v[60:63], v[92:107]
    s_waitcnt lgkmcnt(0)
    s_cmp_ge_u32 s5, 4
    s_cbranch_scc1 K1_W_9
    s_waitcnt vmcnt(4)
    s_branch K1_W_10
K1_W_9:
    s_waitcnt vmcnt(3)
K1_W_10:
    s_barrier
    v_mfma_f32_32x32x16_bf16 v[76:91], v[64:67], v[72:75], v[76:91]
    ds_read_b128 v[60:63], v8 offset:32768
    ds_read_b64_tr_b16 v[52:53], v12 offset:24576
    ds_read_b64_tr_b16 v[54:55], v12 offset:25344
    ds_read_b64_tr_b16 v[56:57], v13 offset:24576
    ds_read_b64_tr_b16 v[58:59], v13 offset:25344
    v_mfma_f32_32x32x16_bf16 v[92:107], v[68:71], v[72:75], v[92:107]
    s_waitcnt lgkmcnt(0)
    v_mfma_f32_32x32x16_bf16 v[76:91], v[52:55], v[60:63], v[76:91]
    ds_read_b128 v[72:75], v9 offset:32768
    ds_read_b64_tr_b16 v[64:65], v12 offset:27648
    ds_read_b64_tr_b16 v[66:67], v12 offset:28416
    ds_read_b64_tr_b16 v[68:69], v13 offset:27648
    ds_read_b64_tr_b16 v[70:71], v13 offset:28416
    v_mfma_f32_32x32x16_bf16 v[92:107], v[56:59], v[60:63], v[92:107]
    s_mov_b32 s60, 786432
    s_mov_b32 s61, 704512
    s_mov_b32 s62, 512
    s_add_u32 m0, s67, 16384
    s_nop 0
    buffer_load_dwordx4 v4, s[8:11], s62 offen lds
    s_add_u32 m0, s67, 61440
    s_nop 0
    buffer_load_dwordx4 v6, s[12:15], s60 offen lds
    s_add_u32 m0, s67, 98304
    s_nop 0
    buffer_load_dwordx4 v7, s[16:19], s61 offen lds
    s_cmp_ge_u32 s5, 4
    s_cbranch_scc1 K1_NOX2_11
    s_add_u32 m0, s67, 28672
    s_nop 0
    buffer_load_dwordx4 v5, s[8:11], s62 offen lds
K1_NOX2_11:
    s_waitcnt lgkmcnt(0)
    v_mfma_f32_32x32x16_bf16 v[76:91], v[64:67], v[72:75], v[76:91]
    ds_read_b128 v[60:63], v10 offset:32768
    ds_read_b64_tr_b16 v[52:53], v12 offset:30720
    ds_read_b64_tr_b16 v[54:55], v12 offset:31488
    ds_read_b64_tr_b16 v[56:57], v13 offset:30720
    ds_read_b64_tr_b16 v[58:59], v13 offset:31488
    v_mfma_f32_32x32x16_bf16 v[92:107], v[68:71], v[72:75], v[92:107]
    s_waitcnt lgkmcnt(0)
    v_mfma_f32_32x32x16_bf16 v[76:91], v[52:55], v[60:63], v[76:91]
    ds_read_b128 v[72:75], v11 offset:32768
    ds_read_b64_tr_b16 v[64:65], v12 offset:33792
    ds_read_b64_tr_b16 v[66:67], v12 offset:34560
    ds_read_b64_tr_b16 v[68:69], v13 offset:33792
    ds_read_b64_tr_b16 v[70:71], v13 offset:34560
    v_mfma_f32_32x32x16_bf16 v[92:107], v[56:59], v[60:63], v[92:107]
    s_waitcnt lgkmcnt(0)
    s_cmp_ge_u32 s5, 4
    s_cbranch_scc1 K1_W_12
    s_waitcnt vmcnt(4)
    s_branch K1_W_13
K1_W_12:
    s_waitcnt vmcnt(3)
K1_W_13:
    s_barrier
    v_mfma_f32_32x32x16_bf16 v[76:91], v[64:67], v[72:75], v[76:91]
    ds_read_b128 v[60:63], v8 offset:0
    ds_read_b64_tr_b16 v[52:53], v12 offset:0
    ds_read_b64_tr_b16 v[54:55], v12 offset:768
    ds_read_b64_tr_b16 v[56:57], v13 offset:0
    ds_read_b64_tr_b16 v[58:59], v13 offset:768
    v_mfma_f32_32x32x16_bf16 v[92:107], v[68:71], v[72:75], v[92:107]
    s_waitcnt lgkmcnt(0)
    v_mfma_f32_32x32x16_bf16 v[76:91], v[52:55], v[60:63], v[76:91]
    ds_read_b128 v[72:75], v9 offset:0
    ds_read_b64_tr_b16 v[64:65], v12 offset:3072
    ds_read_b64_tr_b16 v[66:67], v12 offset:3840
    ds_read_b64_tr_b16 v[68:69], v13 offset:3072
    ds_read_b64_tr_b16 v[70:71], v13 offset:3840
    v_mfma_f32_32x32x16_bf16 v[92:107], v[56:59], v[60:63], v[92:107]
    s_mov_b32 s60, 983040
    s_mov_b32 s61, 880640
    s_mov_b32 s62, 640
    s_add_u32 m0, s67, 32768
    s_nop 0
    buffer_load_dwordx4 v4, s[8:11], s62 offen lds
    s_add_u32 m0, s67, 73728
    s_nop 0
    buffer_load_dwordx4 v6, s[12:15], s60 offen lds
    s_add_u32 m0, s67, 110592
    s_nop 0
    buffer_load_dwordx4 v7, s[16:19], s61 offen lds
    s_cmp_ge_u32 s5, 4
    s_cbranch_scc1 K1_NOX2_14
    s_add_u32 m0, s67, 45056
    s_nop 0
    buffer_load_dwordx4 v5, s[8:11], s62 offen lds
K1_NOX2_14:
    s_waitcnt lgkmcnt(0)
    v_mfma_f32_32x32x16_bf16 v[76:91], v[64:67], v[72:75], v[76:91]
    ds_read_b128 v[60:63], v10 offset:0
    ds_read_b64_tr_b16 v[52:53], v12 offset:6144
    ds_read_b64_tr_b16 v[54:55], v12 offset:6912
    ds_read_b64_tr_b16 v[56:57], v13 offset:6144
    ds_read_b64_tr_b16 v[58:59], v13 offset:6912
    v_mfma_f32_32x32x16_bf16 v[92:107], v[68:71], v[72:75], v[92:107]
    s_waitcnt lgkmcnt(0)
    v_mfma_f32_32x32x16_bf16 v[76:91], v[52:55], v[60:63], v[76:91]
    ds_read_b128 v[72:75], v11 offset:0
    ds_read_b64_tr_b16 v[64:65], v12 offset:9216
    ds_read_b64_tr_b16 v[66:67], v12 offset:9984
    ds_read_b64_tr_b16 v[68:69], v13 offset:9216
    ds_read_b64_tr_b16 v[70:71], v13 offset:9984
    v_mfma_f32_32x32x16_bf16 v[92:107], v[56:59], v[60:63], v[92:107]
    s_waitcnt lgkmcnt(0)
    s_cmp_ge_u32 s5, 4
    s_cbranch_scc1 K1_W_15
    s_waitcnt vmcnt(4)
    s_branch K1_W_16
K1_W_15:
    s_waitcnt vmcnt(3)
K1_W_16:
    s_barrier
    v_mfma_f32_32x32x16_bf16 v[76:91], v[64:67], v[72:75], v[76:91]
    ds_read_b128 v[60:63], v8 offset:16384
    ds_read_b64_tr_b16 v[52:53], v12 offset:12288
    ds_read_b64_tr_b16 v[54:55], v12 offset:13056
    ds_read_b64_tr_b16 v[56:57], v13 offset:12288
    ds_read_b64_tr_b16 v[58:59], v13 offset:13056
    v_mfma_f32_32x32x16_bf16 v[92:107], v[68:71], v[72:75], v[92:107]
    s_waitcnt lgkmcnt(0)
    v_mfma_f32_32x32x16_bf16 v[76:91], v[52:55], v[60:63], v[76:91]
    ds_read_b128 v[72:75], v9 offset:16384
    ds_read_b64_tr_b16 v[64:65], v12 offset:15360
    ds_read_b64_tr_b16 v[66:67], v12 offset:16128
    ds_read_b64_tr_b16 v[68:69], v13 offset:15360
    ds_read_b64_tr_b16 v[70:71], v13 offset:16128
    v_mfma_f32_32x32x16_bf16 v[92:107], v[56:59], v[60:63], v[92:107]
    s_mov_b32 s60, 1179648
    s_mov_b32 s61, 1056768
    s_mov_b32 s62, 768
    s_add_u32 m0, s67, 0
    s_nop 0
    buffer_load_dwordx4 v4, s[8:11], s62 offen lds
    s_add_u32 m0, s67, 49152
    s_nop 0
    buffer_load_dwordx4 v6, s[12:15], s60 offen lds
    s_add_u32 m0, s67, 86016
    s_nop 0
    buffer_load_dwordx4 v7, s[16:19], s61 offen lds
    s_cmp_ge_u32 s5, 4
    s_cbranch_scc1 K1_NOX2_17
    s_add_u32 m0, s67, 12288
    s_nop 0
    buffer_load_dwordx4 v5, s[8:11], s62 offen lds
K1_NOX2_17:
    s_waitcnt lgkmcnt(0)
    v_mfma_f32_32x32x16_bf16 v[76:91], v[64:67], v[72:75], v[76:91]
    ds_read_b128 v[60:63], v10 offset:16384
    ds_read_b64_tr_b16 v[52:53], v12 offset:18432
    ds_read_b64_tr_b16 v[54:55], v12 offset:19200
    ds_read_b64_tr_b16 v[56:57], v13 offset:18432
    ds_read_b64_tr_b16 v[58:59], v13 offset:19200
    v_mfma_f32_32x32x16_bf16 v[92:107], v[68:71], v[72:75], v[92:107]
    s_waitcnt lgkmcnt(0)
    v_mfma_f32_32x32x16_bf16 v[76:91], v[52:55], v[60:63], v[76:91]
    ds_read_b128 v[72:75], v11 offset:16384
    ds_read_b64_tr_b16 v[64:65], v12 offset:21504
    ds_read_b64_tr_b16 v[66:67], v12 offset:22272
    ds_read_b64_tr_b16 v[68:69], v13 offset:21504
    ds_read_b64_tr_b16 v[70:71], v13 offset:22272
    v_mfma_f32_32x32x16_bf16 v[92:107], v[56:59], v[60:63], v[92:107]
    s_waitcnt lgkmcnt(0)
    s_cmp_ge_u32 s5, 4
    s_cbranch_scc1 K1_W_18
    s_waitcnt vmcnt(4)
    s_branch K1_W_19
K1_W_18:
    s_waitcnt vmcnt(3)
K1_W_19:
    s_barrier
    v_mfma_f32_32x32x16_bf16 v[76:91], v[64:67], v[72:75], v[76:91]
    ds_read_b128 v[60:63], v8 offset:32768
    ds_read_b64_tr_b16 v[52:53], v12 offset:24576
    ds_read_b64_tr_b16 v[54:55], v12 offset:25344
    ds_read_b64_tr_b16 v[56:57], v13 offset:24576
    ds_read_b64_tr_b16 v[58:59], v13 offset:25344
    v_mfma_f32_32x32x16_bf16 v[92:107], v[68:71], v[72:75], v[92:107]
    s_waitcnt lgkmcnt(0)
    v_mfma_f32_32x32x16_bf16 v[76:91], v[52:55], v[60:63], v[76:91]
    ds_read_b128 v[72:75], v9 offset:32768
    ds_read_b64_tr_b16 v[64:65], v12 offset:27648
    ds_read_b64_tr_b16 v[66:67], v12 offset:28416
    ds_read_b64_tr_b16 v[68:69], v13 offset:27648
    ds_read_b64_tr_b16 v[70:71], v13 offset:28416
    v_mfma_f32_32x32x16_bf16 v[92:107], v[56:59], v[60:63], v[92:107]
    s_mov_b32 s60, 1376256
    s_mov_b32 s61, 1232896
    s_mov_b32 s62, 896
    s_add_u32 m0, s67, 16384
    s_nop 0
    buffer_load_dwordx4 v4, s[8:11], s62 offen lds
    s_add_u32 m0, s67, 61440
    s_nop 0
    buffer_load_dwordx4 v6, s[12:15], s60 offen lds
    s_add_u32 m0, s67, 98304
    s_nop 0
    buffer_load_dwordx4 v7, s[16:19], s61 offen lds
    s_cmp_ge_u32 s5, 4
    s_cbranch_scc1 K1_NOX2_20
    s_add_u32 m0, s67, 28672
    s_nop 0
    buffer_load_dwordx4 v5, s[8:11], s62 offen lds
K1_NOX2_20:
    s_waitcnt lgkmcnt(0)
    v_mfma_f32_32x32x16_bf16 v[76:91], v[64:67], v[72:75], v[76:91]
    ds_read_b128 v[60:63], v10 offset:32768
    ds_read_b64_tr_b16 v[52:53], v12 offset:30720
    ds_read_b64_tr_b16 v[54:55], v12 offset:31488
    ds_read_b64_tr_b16 v[56:57], v13 offset:30720
    ds_read_b64_tr_b16 v[58:59], v13 offset:31488
    v_mfma_f32_32x32x16_bf16 v[92:107], v[68:71], v[72:75], v[92:107]
    s_waitcnt lgkmcnt(0)
    v_mfma_f32_32x32x16_bf16 v[76:91], v[52:55], v[60:63], v[76:91]
    ds_read_b128 v[72:75], v11 offset:32768
    ds_read_b64_tr_b16 v[64:65], v12 offset:33792
    ds_read_b64_tr_b16 v[66:67], v12 offset:34560
    ds_read_b64_tr_b16 v[68:69], v13 offset:33792
    ds_read_b64_tr_b16 v[70:71], v13 offset:34560
    v_mfma_f32_32x32x16_bf16 v[92:107], v[56:59], v[60:63], v[92:107]
    s_waitcnt lgkmcnt(0)
    s_cmp_ge_u32 s5, 4
    s_cbranch_scc1 K1_W_21
    s_waitcnt vmcnt(4)
    s_branch K1_W_22
K1_W_21:
    s_waitcnt vmcnt(3)
K1_W_22:
    s_barrier
    v_mfma_f32_32x32x16_bf16 v[76:91], v[64:67], v[72:75], v[76:91]
    ds_read_b128 v[60:63], v8 offset:0
    ds_read_b64_tr_b16 v[52:53], v12 offset:0
    ds_read_b64_tr_b16 v[54:55], v12 offset:768
    ds_read_b64_tr_b16 v[56:57], v13 offset:0
    ds_read_b64_tr_b16 v[58:59], v13 offset:768
    v_mfma_f32_32x32x16_bf16 v[92:107], v[68:71], v[72:75], v[92:107]
    s_waitcnt lgkmcnt(0)
    v_mfma_f32_32x32x16_bf16 v[76:91], v[52:55], v[60:63], v[76:91]
    ds_read_b128 v[72:75], v9 offset:0
    ds_read_b64_tr_b16 v[64:65], v12 offset:3072
    ds_read_b64_tr_b16 v[66:67], v12 offset:3840
    ds_read_b64_tr_b16 v[68:69], v13 offset:3072
    ds_read_b64_tr_b16 v[70:71], v13 offset:3840
    v_mfma_f32_32x32x16_bf16 v[92:107], v[56:59], v[60:63], v[92:107]
    s_waitcnt lgkmcnt(0)
    v_mfma_f32_32x32x16_bf16 v[76:91], v[64:67], v[72:75], v[76:91]
    ds_read_b128 v[60:63], v10 offset:0
    ds_read_b64_tr_b16 v[52:53], v12 offset:6144
    ds_read_b64_tr_b16 v[54:55], v12 offset:6912
    ds_read_b64_tr_b16 v[56:57], v13 offset:6144
    ds_read_b64_tr_b16 v[58:59], v13 offset:6912
    v_mfma_f32_32x32x16_bf16 v[92:107], v[68:71], v[72:75], v[92:107]
    s_waitcnt lgkmcnt(0)
    v_mfma_f32_32x32x16_bf16 v[76:91], v[52:55], v[60:63], v[76:91]
    ds_read_b128 v[72:75], v11 offset:0
    ds_read_b64_tr_b16 v[64:65], v12 offset:9216
    ds_read_b64_tr_b16 v[66:67], v12 offset:9984
    ds_read_b64_tr_b16 v[68:69], v13 offset:9216
    ds_read_b64_tr_b16 v[70:71], v13 offset:9984
    v_mfma_f32_32x32x16_bf16 v[92:107], v[56:59], v[60:63], v[92:107]
    s_waitcnt lgkmcnt(0)
    s_cmp_ge_u32 s5, 4
    s_cbranch_scc1 K1_W_23
    s_waitcnt vmcnt(0)
    s_branch K1_W_24
K1_W_23:
    s_waitcnt vmcnt(0)
K1_W_24:
    s_barrier
    v_mfma_f32_32x32x16_bf16 v[76:91], v[64:67], v[72:75], v[76:91]
    ds_read_b128 v[60:63], v8 offset:16384
    ds_read_b64_tr_b16 v[52:53], v12 offset:12288
    ds_read_b64_tr_b16 v[54:55], v12 offset:13056
    ds_read_b64_tr_b16 v[56:57], v13 offset:12288
    ds_read_b64_tr_b16 v[58:59], v13 offset:13056
    v_mfma_f32_32x32x16_bf16 v[92:107], v[68:71], v[72:75], v[92:107]
    s_waitcnt lgkmcnt(0)
    v_mfma_f32_32x32x16_bf16 v[76:91], v[52:55], v[60:63], v[76:91]
    ds_read_b128 v[72:75], v9 offset:16384
    ds_read_b64_tr_b16 v[64:65], v12 offset:15360
    ds_read_b64_tr_b16 v[66:67], v12 offset:16128
    ds_read_b64_tr_b16 v[68:69], v13 offset:15360
    ds_read_b64_tr_b16 v[70:71], v13 offset:16128
    v_mfma_f32_32x32x16_bf16 v[92:107], v[56:59], v[60:63], v[92:107]
    buffer_load_dwordx2 v[44:45], v17, s[24:27], s71 offen offset:0
    buffer_load_dwordx2 v[46:47], v17, s[24:27], s71 offen offset:16
    buffer_load_dwordx2 v[48:49], v17, s[24:27], s71 offen offset:32
    buffer_load_dwordx2 v[50:51], v17, s[24:27], s71 offen offset:48
    s_cmp_lg_u32 s7, 0
    s_cbranch_scc1 K1_NOSIDE_25
    buffer_load_dwordx4 v[24:27], v15, s[28:31], s57 offen
    buffer_load_dwordx4 v[28:31], v15, s[28:31], s58 offen
K1_NOSIDE_25:
    s_cmp_lg_u32 s7, 1
    s_cbranch_scc1 K1_NOSIDE_26
    buffer_load_dwordx4 v[32:35], v16, s[8:11], s68 offen
    buffer_load_dwordx4 v[36:39], v16, s[8:11], s69 offen
    buffer_load_dwordx4 v[40:43], v16, s[32:35], 0 offen
K1_NOSIDE_26:
    s_waitcnt lgkmcnt(0)
    v_mfma_f32_32x32x16_bf16 v[76:91], v[64:67], v[72:75], v[76:91]
    ds_read_b128 v[60:63], v10 offset:16384
    ds_read_b64_tr_b16 v[52:53], v12 offset:18432
    ds_read_b64_tr_b16 v[54:55], v12 offset:19200
    ds_read_b64_tr_b16 v[56:57], v13 offset:18432
    ds_read_b64_tr_b16 v[58:59], v13 offset:19200
    v_mfma_f32_32x32x16_bf16 v[92:107], v[68:71], v[72:75], v[92:107]
    s_waitcnt lgkmcnt(0)
    v_mfma_f32_32x32x16_bf16 v[76:91], v[52:55], v[60:63], v[76:91]
    ds_read_b128 v[72:75], v11 offset:16384
    ds_read_b64_tr_b16 v[64:65], v12 offset:21504
    ds_read_b64_tr_b16 v[66:67], v12 offset:22272
    ds_read_b64_tr_b16 v[68:69], v13 offset:21504
    ds_read_b64_tr_b16 v[70:71], v13 offset:22272
    v_mfma_f32_32x32x16_bf16 v[92:107], v[56:59], v[60:63], v[92:107]
    s_waitcnt lgkmcnt(0)
    v_mfma_f32_32x32x16_bf16 v[76:91], v[64:67], v[72:75], v[76:91]
    v_mfma_f32_32x32x16_bf16 v[92:107], v[68:71], v[72:75], v[92:107]
    s_barrier
    s_waitcnt vmcnt(0)
    s_cmp_ge_u32 s5, 4
    s_cbranch_scc1 K1_NOT1
    v_lshrrev_b32 v18, 4, v0
    v_and_b32 v19, 15, v0
    v_mul_u32_u24 v18, 320, v18
    v_lshl_add_u32 v18, v19, 4, v18
    ds_write_b128 v18, v[24:27]
    ds_write_b128 v18, v[28:31] offset:5120
K1_NOT1:
    s_nop 15
    s_mul_i32 s60, s4, 3
    s_add_u32 s60, s60, s7
    s_lshr_b32 s61, s60, 4
    s_and_b32 s62, s60, 15
    s_lshl_b32 s63, s61, 21
    s_lshl_b32 s62, s62, 17
    s_add_u32 s63, s63, s62
    s_add_u32 s64, s63, 65536
    s_cmp_eq_u32 s61, 0
    s_cselect_b32 s86, 1052289595, 1.0
    s_cselect_b32 s87, 1052289595, 1.0
    v_pk_mul_f32 v[76:77], v[76:77], s[86:87]
    v_pk_mul_f32 v[78:79], v[78:79], s[86:87]
    v_pk_mul_f32 v[80:81], v[80:81], s[86:87]
    v_pk_mul_f32 v[82:83], v[82:83], s[86:87]
    v_pk_mul_f32 v[84:85], v[84:85], s[86:87]
    v_pk_mul_f32 v[86:87], v[86:87], s[86:87]
    v_pk_mul_f32 v[88:89], v[88:89], s[86:87]
    v_pk_mul_f32 v[90:91], v[90:91], s[86:87]
    v_cvt_pk_bf16_f32 v108, v76, v77
    v_cvt_pk_bf16_f32 v109, v78, v79
    v_cvt_pk_bf16_f32 v110, v80, v81
    v_cvt_pk_bf16_f32 v111, v82, v83
    v_cvt_pk_bf16_f32 v112, v84, v85
    v_cvt_pk_bf16_f32 v113, v86, v87
    v_cvt_pk_bf16_f32 v114, v88, v89
    v_cvt_pk_bf16_f32 v115, v90, v91
    v_lshlrev_b32 v18, 5, v14
    v_lshl_add_u32 v18, v3, 4, v18
    v_permlane32_swap_b32 v108, v110
    v_permlane32_swap_b32 v109, v111
    v_permlane32_swap_b32 v112, v114
    s_nop 0
    v_permlane32_swap_b32 v113, v115
    s_nop 1
    buffer_store_dwordx4 v[108:111], v18, s[20:23], s63 offen nt
    buffer_store_dwordx4 v[112:115], v18, s[20:23], s64 offen nt
    s_nop 1
    s_cmp_ge_u32 s60, 43
    s_cbranch_scc1 K1_SKIPF
    s_lshl_b32 s62, s60, 11
    s_add_u32 s61, s62, 6291456
    v_lshlrev_b32 v148, 16, v44
    v_and_b32 v149, 0xffff0000, v44
    v_lshlrev_b32 v150, 16, v45
    v_and_b32 v151, 0xffff0000, v45
    v_lshlrev_b32 v152, 16, v46
    v_and_b32 v153, 0xffff0000, v46
    v_lshlrev_b32 v154, 16, v47
    v_and_b32 v155, 0xffff0000, v47
    v_lshlrev_b32 v156, 16, v48
    v_and_b32 v157, 0xffff0000, v48
    v_lshlrev_b32 v158, 16, v49
    v_and_b32 v159, 0xffff0000, v49
    v_lshlrev_b32 v160, 16, v50
    v_and_b32 v161, 0xffff0000, v50
    v_lshlrev_b32 v162, 16, v51
    v_and_b32 v163, 0xffff0000, v51
    v_pk_add_f32 v[92:93], v[92:93], v[148:149]
    v_pk_add_f32 v[94:95], v[94:95], v[150:151]
    v_pk_add_f32 v[96:97], v[96:97], v[152:153]
    v_pk_add_f32 v[98:99], v[98:99], v[154:155]
    v_pk_add_f32 v[100:101], v[100:101], v[156:157]
    v_pk_add_f32 v[102:103], v[102:103], v[158:159]
    v_pk_add_f32 v[104:105], v[104:105], v[160:161]
    v_pk_add_f32 v[106:107], v[106:107], v[162:163]
    v_min_f32 v116, 0x41a00000, v92
    v_min_f32 v117, 0x41a00000, v93
    v_min_f32 v118, 0x41a00000, v94
    v_min_f32 v119, 0x41a00000, v95
    v_min_f32 v120, 0x41a00000, v96
    v_min_f32 v121, 0x41a00000, v97
    v_min_f32 v122, 0x41a00000, v98
    v_min_f32 v123, 0x41a00000, v99
    v_min_f32 v124, 0x41a00000, v100
    v_min_f32 v125, 0x41a00000, v101
    v_min_f32 v126, 0x41a00000, v102
    v_min_f32 v127, 0x41a00000, v103
    v_min_f32 v128, 0x41a00000, v104
    v_min_f32 v129, 0x41a00000, v105
    v_min_f32 v130, 0x41a00000, v106
    v_min_f32 v131, 0x41a00000, v107
    v_pk_mul_f32 v[116:117], v[116:117], s[82:83]
    v_pk_mul_f32 v[118:119], v[118:119], s[82:83]
    v_pk_mul_f32 v[120:121], v[120:121], s[82:83]
    v_pk_mul_f32 v[122:123], v[122:123], s[82:83]
    v_pk_mul_f32 v[124:125], v[124:125], s[82:83]
    v_pk_mul_f32 v[126:127], v[126:127], s[82:83]
    v_pk_mul_f32 v[128:129], v[128:129], s[82:83]
    v_pk_mul_f32 v[130:131], v[130:131], s[82:83]
    v_exp_f32 v116, v116
    v_exp_f32 v117, v117
    v_exp_f32 v118, v118
    v_exp_f32 v119, v119
    v_exp_f32 v120, v120
    v_exp_f32 v121, v121
    v_exp_f32 v122, v122
    v_exp_f32 v123, v123
    v_exp_f32 v124, v124
    v_exp_f32 v125, v125
    v_exp_f32 v126, v126
    v_exp_f32 v127, v127
    v_exp_f32 v128, v128
    v_exp_f32 v129, v129
    v_exp_f32 v130, v130
    v_exp_f32 v131, v131
    v_pk_add_f32 v[132:133], v[116:117], s[80:81]
    v_pk_add_f32 v[134:135], v[118:119], s[80:81]
    v_pk_add_f32 v[136:137], v[120:121], s[80:81]
    v_pk_add_f32 v[138:139], v[122:123], s[80:81]
    v_pk_add_f32 v[140:141], v[124:125], s[80:81]
    v_pk_add_f32 v[142:143], v[126:127], s[80:81]
    v_pk_add_f32 v[144:145], v[128:129], s[80:81]
    v_pk_add_f32 v[146:147], v[130:131], s[80:81]
    v_pk_mul_f32 v[116:117], v[116:117], v[132:133]
    v_pk_mul_f32 v[118:119], v[118:119], v[134:135]
    v_pk_mul_f32 v[120:121], v[120:121], v[136:137]
    v_pk_mul_f32 v[122:123], v[122:123], v[138:139]
    v_pk_mul_f32 v[124:125], v[124:125], v[140:141]
    v_pk_mul_f32 v[126:127], v[126:127], v[142:143]
    v_pk_mul_f32 v[128:129], v[128:129], v[144:145]
    v_pk_mul_f32 v[130:131], v[130:131], v[146:147]
    v_pk_add_f32 v[132:133], v[116:117], s[80:81]
    v_pk_add_f32 v[134:135], v[118:119], s[80:81]
    v_pk_add_f32 v[136:137], v[120:121], s[80:81]
    v_pk_add_f32 v[138:139], v[122:123], s[80:81]
    v_pk_add_f32 v[140:141], v[124:125], s[80:81]
    v_pk_add_f32 v[142:143], v[126:127], s[80:81]
    v_pk_add_f32 v[144:145], v[128:129], s[80:81]
    v_pk_add_f32 v[146:147], v[130:131], s[80:81]
    v_rcp_f32 v132, v132
    v_rcp_f32 v133, v133
    v_rcp_f32 v134, v134
    v_rcp_f32 v135, v135
    v_rcp_f32 v136, v136
    v_rcp_f32 v137, v137
    v_rcp_f32 v138, v138
    v_rcp_f32 v139, v139
    v_rcp_f32 v140, v140
    v_rcp_f32 v141, v141
    v_rcp_f32 v142, v142
    v_rcp_f32 v143, v143
    v_rcp_f32 v144, v144
    v_rcp_f32 v145, v145
    v_rcp_f32 v146, v146
    v_rcp_f32 v147, v147
    v_pk_mul_f32 v[116:117], v[116:117], v[132:133]
    v_pk_mul_f32 v[118:119], v[118:119], v[134:135]
    v_pk_mul_f32 v[120:121], v[120:121], v[136:137]
    v_pk_mul_f32 v[122:123], v[122:123], v[138:139]
    v_pk_mul_f32 v[124:125], v[124:125], v[140:141]
    v_pk_mul_f32 v[126:127], v[126:127], v[142:143]
    v_pk_mul_f32 v[128:129], v[128:129], v[144:145]
    v_pk_mul_f32 v[130:131], v[130:131], v[146:147]
    v_pk_mul_f32 v[92:93], v[92:93], v[116:117]
    v_pk_mul_f32 v[94:95], v[94:95], v[118:119]
    v_pk_mul_f32 v[96:97], v[96:97], v[120:121]
    v_pk_mul_f32 v[98:99], v[98:99], v[122:123]
    v_pk_mul_f32 v[100:101], v[100:101], v[124:125]
    v_pk_mul_f32 v[102:103], v[102:103], v[126:127]
    v_pk_mul_f32 v[104:105], v[104:105], v[128:129]
    v_pk_mul_f32 v[106:107], v[106:107], v[130:131]
    v_cvt_pk_bf16_f32 v108, v92, v93
    v_cvt_pk_bf16_f32 v109, v94, v95
    v_cvt_pk_bf16_f32 v110, v96, v97
    v_cvt_pk_bf16_f32 v111, v98, v99
    v_cvt_pk_bf16_f32 v112, v100, v101
    v_cvt_pk_bf16_f32 v113, v102, v103
    v_cvt_pk_bf16_f32 v114, v104, v105
    v_cvt_pk_bf16_f32 v115, v106, v107
    s_lshr_b32 s62, s66, 5
    s_mul_i32 s62, s62, 88064
    s_add_u32 s61, s61, s62
    v_permlane32_swap_b32 v108, v110
    v_permlane32_swap_b32 v109, v111
    v_permlane32_swap_b32 v112, v114
    v_permlane32_swap_b32 v113, v115
    s_nop 1
    buffer_store_dwordx4 v[108:111], v16, s[20:23], s61 offen nt
    buffer_store_dwordx4 v[112:115], v16, s[20:23], s61 offen offset:1024 nt
    s_nop 1
K1_SKIPF:
    s_waitcnt lgkmcnt(0)
    s_barrier
    s_cmp_eq_u32 s7, 0
    s_cbranch_scc1 K1_TRANS
    s_cmp_lg_u32 s7, 1
    s_cbranch_scc1 K1_END
    v_lshlrev_b32 v108, 16, v40
    v_and_b32 v109, 0xffff0000, v40
    v_lshlrev_b32 v110, 16, v41
    v_and_b32 v111, 0xffff0000, v41
    v_lshlrev_b32 v112, 16, v42
    v_and_b32 v113, 0xffff0000, v42
    v_lshlrev_b32 v114, 16, v43
    v_and_b32 v115, 0xffff0000, v43
    v_lshlrev_b32 v116, 16, v32
    v_and_b32 v117, 0xffff0000, v32
    v_lshlrev_b32 v118, 16, v33
    v_and_b32 v119, 0xffff0000, v33
    v_lshlrev_b32 v120, 16, v34
    v_and_b32 v121, 0xffff0000, v34
    v_lshlrev_b32 v122, 16, v35
    v_and_b32 v123, 0xffff0000, v35
    v_mul_f32 v116, v116, v108
    v_mul_f32 v117, v117, v109
    v_mul_f32 v118, v118, v110
    v_mul_f32 v119, v119, v111
    v_mul_f32 v120, v120, v112
    v_mul_f32 v121, v121, v113
    v_mul_f32 v122, v122, v114
    v_mul_f32 v123, v123, v115
    v_cvt_pk_bf16_f32 v124, v116, v117
    v_cvt_pk_bf16_f32 v125, v118, v119
    v_cvt_pk_bf16_f32 v126, v120, v121
    v_cvt_pk_bf16_f32 v127, v122, v123
    v_lshlrev_b32 v116, 16, v124
    v_and_b32 v117, 0xffff0000, v124
    v_lshlrev_b32 v118, 16, v125
    v_and_b32 v119, 0xffff0000, v125
    v_lshlrev_b32 v120, 16, v126
    v_and_b32 v121, 0xffff0000, v126
    v_lshlrev_b32 v122, 16, v127
    v_and_b32 v123, 0xffff0000, v127
    v_add_f32 v116, v116, v117
    v_add_f32 v118, v118, v119
    v_add_f32 v120, v120, v121
    v_add_f32 v122, v122, v123
    v_add_f32 v116, v116, v118
    v_add_f32 v120, v120, v122
    v_add_f32 v20, v116, v120
    v_lshlrev_b32 v116, 16, v36
    v_and_b32 v117, 0xffff0000, v36
    v_lshlrev_b32 v118, 16, v37
    v_and_b32 v119, 0xffff0000, v37
    v_lshlrev_b32 v120, 16, v38
    v_and_b32 v121, 0xffff0000, v38
    v_lshlrev_b32 v122, 16, v39
    v_and_b32 v123, 0xffff0000, v39
    v_mul_f32 v116, v116, v108
    v_mul_f32 v117, v117, v109
    v_mul_f32 v118, v118, v110
    v_mul_f32 v119, v119, v111
    v_mul_f32 v120, v120, v112
    v_mul_f32 v121, v121, v113
    v_mul_f32 v122, v122, v114
    v_mul_f32 v123, v123, v115
    v_cvt_pk_bf16_f32 v124, v116, v117
    v_cvt_pk_bf16_f32 v125, v118, v119
    v_cvt_pk_bf16_f32 v126, v120, v121
    v_cvt_pk_bf16_f32 v127, v122, v123
    v_lshlrev_b32 v116, 16, v124
    v_and_b32 v117, 0xffff0000, v124
    v_lshlrev_b32 v118, 16, v125
    v_and_b32 v119, 0xffff0000, v125
    v_lshlrev_b32 v120, 16, v126
    v_and_b32 v121, 0xffff0000, v126
    v_lshlrev_b32 v122, 16, v127
    v_and_b32 v123, 0xffff0000, v127
    v_add_f32 v116, v116, v117
    v_add_f32 v118, v118, v119
    v_add_f32 v120, v120, v121
    v_add_f32 v122, v122, v123
    v_add_f32 v116, v116, v118
    v_add_f32 v120, v120, v122
    v_add_f32 v21, v116, v120
    s_nop 1
    v_add_f32_dpp v20, v20, v20 row_shr:1 row_mask:0xf bank_mask:0xf bound_ctrl:0
    v_add_f32_dpp v21, v21, v21 row_shr:1 row_mask:0xf bank_mask:0xf bound_ctrl:0
    s_nop 1
    v_add_f32_dpp v20, v20, v20 row_shr:2 row_mask:0xf bank_mask:0xf bound_ctrl:0
    v_add_f32_dpp v21, v21, v21 row_shr:2 row_mask:0xf bank_mask:0xf bound_ctrl:0
    s_nop 1
    v_add_f32_dpp v20, v20, v20 row_shr:4 row_mask:0xf bank_mask:0xf bound_ctrl:0
    v_add_f32_dpp v21, v21, v21 row_shr:4 row_mask:0xf bank_mask:0xf bound_ctrl:0
    s_nop 1
    v_add_f32_dpp v20, v20, v20 row_shr:8 row_mask:0xf bank_mask:0xf bound_ctrl:0
    v_add_f32_dpp v21, v21, v21 row_shr:8 row_mask:0xf bank_mask:0xf bound_ctrl:0
    s_nop 1
    v_add_f32_dpp v20, v20, v20 row_bcast:15 row_mask:0xa bank_mask:0xf
    v_add_f32_dpp v21, v21, v21 row_bcast:15 row_mask:0xa bank_mask:0xf
    s_nop 1
    v_add_f32_dpp v20, v20, v20 row_bcast:31 row_mask:0xc bank_mask:0xf
    v_add_f32_dpp v21, v21, v21 row_bcast:31 row_mask:0xc bank_mask:0xf
    v_cvt_pk_bf16_f32 v108, v20, v21
    v_lshlrev_b32 v109, 16, v108
    v_and_b32 v110, 0xffff0000, v108
    v_mul_f32 v109, 0xbfb8aa3b, v109
    v_mul_f32 v110, 0xbfb8aa3b, v110
    v_exp_f32 v109, v109
    v_exp_f32 v110, v110
    s_nop 0
    v_add_f32 v109, 1.0, v109
    v_add_f32 v110, 1.0, v110
    v_rcp_f32 v109, v109
    v_rcp_f32 v110, v110
    s_nop 0
    v_cvt_pk_bf16_f32 v108, v109, v110
    v_lshlrev_b32 v112, 16, v108
    v_and_b32 v113, 0xffff0000, v108
    v_sub_f32 v114, 1.0, v112
    v_sub_f32 v115, 1.0, v113
    v_cvt_pk_bf16_f32 v108, v114, v115
    v_lshlrev_b32 v114, 16, v108
    v_and_b32 v115, 0xffff0000, v108
    s_lshl_b32 s60, s59, 2
    s_add_u32 s61, s60, 15736832
    s_add_u32 s60, s60, 15728640
    v_mov_b32 v22, 0
    v_cmp_eq_u32 vcc, 63, v1
    s_and_saveexec_b64 s[88:89], vcc
    buffer_store_dwordx2 v[112:113], v22, s[20:23], s60 offen
    buffer_store_dwordx2 v[114:115], v22, s[20:23], s61 offen
    s_lshl_b32 s60, s2, 2
    s_add_u32 s60, s60, 15761408
    buffer_store_dword v22, v22, s[20:23], s60 offen
    s_mov_b64 exec, s[88:89]
    s_branch K1_END
K1_TRANS:
    s_cmp_ge_u32 s2, 236
    s_cbranch_scc1 K1_END
    v_bfe_u32 v18, v0, 2, 2
    v_lshl_add_u32 v18, v3, 3, v18
    v_mul_u32_u24 v18, 320, v18
    v_and_b32 v19, 3, v0
    v_lshlrev_b32 v19, 3, v19
    v_bfe_u32 v22, v0, 4, 1
    v_lshl_add_u32 v19, v22, 5, v19
    v_add_u32 v18, v18, v19
    s_lshl_b32 s60, s5, 6
    v_add_u32 v18, s60, v18
    ds_read_b64_tr_b16 v[140:141], v18 offset:0
    ds_read_b64_tr_b16 v[142:143], v18 offset:1280
    ds_read_b64_tr_b16 v[144:145], v18 offset:5120
    ds_read_b64_tr_b16 v[146:147], v18 offset:6400
    s_mov_b32 s71, 14680064
    s_cmp_lt_u32 s2, 172
    s_cselect_b32 s61, 86, 32
    s_cselect_b32 s62, 12582912, s71
    s_lshl_b32 s63, s56, 2
    s_add_u32 s63, s63, s5
    s_mul_i32 s63, s63, s61
    s_lshl_b32 s64, s55, 1
    s_add_u32 s63, s63, s64
    s_lshl_b32 s63, s63, 10
    s_add_u32 s62, s62, s63
    s_waitcnt lgkmcnt(0)
    buffer_store_dwordx4 v[140:143], v16, s[20:23], s62 offen nt
    buffer_store_dwordx4 v[144:147], v16, s[20:23], s62 offen offset:1024 nt
K1_END:
K1_END2:
    s_endpgm
.globl gm_k2_kernel
.p2align 8
.type gm_k2_kernel,@function
gm_k2_kernel:
    s_cmp_ge_u32 s2, 256
    s_cbranch_scc1 K2_END
    s_load_dwordx2 s[52:53], s[0:1], 80
    s_load_dwordx4 s[56:59], s[0:1], 64
    v_lshrrev_b32 v1, 6, v0
    s_nop 0
    v_readfirstlane_b32 s5, v1
    v_and_b32 v1, 63, v0
    v_and_b32 v2, 31, v0
    v_bfe_u32 v3, v0, 5, 1
    s_waitcnt lgkmcnt(0)
    s_mov_b32 s8, s52
    s_and_b32 s9, s53, 0xffff
    s_mov_b32 s10, 268435456
    s_mov_b32 s11, 0x00020000
    s_mov_b32 s44, s56
    s_and_b32 s45, s57, 0xffff
    s_mov_b32 s46, 2097152
    s_mov_b32 s47, 0x00020000
    s_cmp_ge_u32 s5, 8
    s_cbranch_scc1 K2_FFN
    s_and_b32 s3, s2, 7
    s_lshl_b32 s3, s3, 2
    s_lshr_b32 s4, s2, 6
    s_add_u32 s3, s3, s4
    s_lshr_b32 s4, s2, 3
    s_and_b32 s4, s4, 7
    s_lshl_b32 s6, s3, 16
    v_lshlrev_b32 v13, 4, v0
    s_add_u32 s7, s6, 2097152
    buffer_load_dwordx4 v[40:43], v13, s[8:11], s7 offen
    s_add_u32 s7, s6, 2105344
    buffer_load_dwordx4 v[44:47], v13, s[8:11], s7 offen
    s_add_u32 s7, s6, 2113536
    buffer_load_dwordx4 v[48:51], v13, s[8:11], s7 offen
    s_add_u32 s7, s6, 2121728
    buffer_load_dwordx4 v[52:55], v13, s[8:11], s7 offen
    s_add_u32 s7, s6, 2129920
    buffer_load_dwordx4 v[56:59], v13, s[8:11], s7 offen
    s_add_u32 s7, s6, 2138112
    buffer_load_dwordx4 v[60:63], v13, s[8:11], s7 offen
    s_add_u32 s7, s6, 2146304
    buffer_load_dwordx4 v[64:67], v13, s[8:11], s7 offen
    s_add_u32 s7, s6, 2154496
    buffer_load_dwordx4 v[68:71], v13, s[8:11], s7 offen
    s_lshl_b32 s12, s4, 8
    s_lshl_b32 s13, s5, 5
    s_add_u32 s12, s12, s13
    v_add_u32 v14, s12, v2
    v_lshlrev_b32 v15, 5, v14
    v_lshl_add_u32 v15, v3, 4, v15
    s_add_u32 s7, s6, 0
    buffer_load_dwordx4 v[4:7], v15, s[8:11], s7 offen
    v_lshlrev_b32 v18, 4, v1
    s_lshl_b32 s13, s5, 10
    s_add_u32 m0, s13, 65536
    s_add_u32 s7, s6, 4194304
    s_add_u32 s7, s7, s13
    buffer_load_dwordx4 v18, s[8:11], s7 offen lds
    s_add_u32 m0, s13, 73728
    s_add_u32 s7, s6, 4202496
    s_add_u32 s7, s7, s13
    buffer_load_dwordx4 v18, s[8:11], s7 offen lds
    s_add_u32 m0, s13, 81920
    s_add_u32 s7, s6, 4210688
    s_add_u32 s7, s7, s13
    buffer_load_dwordx4 v18, s[8:11], s7 offen lds
    s_add_u32 m0, s13, 90112
    s_add_u32 s7, s6, 4218880
    s_add_u32 s7, s7, s13
    buffer_load_dwordx4 v18, s[8:11], s7 offen lds
    s_add_u32 m0, s13, 98304
    s_add_u32 s7, s6, 4227072
    s_add_u32 s7, s7, s13
    buffer_load_dwordx4 v18, s[8:11], s7 offen lds
    s_add_u32 m0, s13, 106496
    s_add_u32 s7, s6, 4235264
    s_add_u32 s7, s7, s13
    buffer_load_dwordx4 v18, s[8:11], s7 offen lds
    s_add_u32 m0, s13, 114688
    s_add_u32 s7, s6, 4243456
    s_add_u32 s7, s7, s13
    buffer_load_dwordx4 v18, s[8:11], s7 offen lds
    s_add_u32 m0, s13, 122880
    s_add_u32 s7, s6, 4251648
    s_add_u32 s7, s7, s13
    buffer_load_dwordx4 v18, s[8:11], s7 offen lds
    v_mov_b32 v104, 0x3f803f80
    v_mov_b32 v105, 0x3f803f80
    v_mov_b32 v106, 0x3f803f80
    v_mov_b32 v107, 0x3f803f80
    v_add_u32 v16, 131072, v13
    ds_write_b128 v16, v[104:107]
    s_lshl_b32 s13, s5, 2
    s_add_u32 s13, s13, 139264
    v_mov_b32 v17, s13
    v_mov_b32 v18, 0
    v_mov_b32 v16, 139264
    ds_write_b32 v16, v18 offset:64
    s_waitcnt vmcnt(9)
    ds_write_b128 v13, v[40:43] offset:0
    ds_write_b128 v13, v[44:47] offset:8192
    ds_write_b128 v13, v[48:51] offset:16384
    ds_write_b128 v13, v[52:55] offset:24576
    ds_write_b128 v13, v[56:59] offset:32768
    ds_write_b128 v13, v[60:63] offset:40960
    ds_write_b128 v13, v[64:67] offset:49152
    ds_write_b128 v13, v[68:71] offset:57344
    v_dot2_f32_bf16 v120, v40, v40, 0
    v_dot2_f32_bf16 v121, v44, v44, 0
    v_dot2_f32_bf16 v122, v48, v48, 0
    v_dot2_f32_bf16 v123, v52, v52, 0
    v_dot2_f32_bf16 v124, v56, v56, 0
    v_dot2_f32_bf16 v125, v60, v60, 0
    v_dot2_f32_bf16 v126, v64, v64, 0
    v_dot2_f32_bf16 v127, v68, v68, 0
    v_dot2_f32_bf16 v120, v41, v41, v120
    v_dot2_f32_bf16 v121, v45, v45, v121
    v_dot2_f32_bf16 v122, v49, v49, v122
    v_dot2_f32_bf16 v123, v53, v53, v123
    v_dot2_f32_bf16 v124, v57, v57, v124
    v_dot2_f32_bf16 v125, v61, v61, v125
    v_dot2_f32_bf16 v126, v65, v65, v126
    v_dot2_f32_bf16 v127, v69, v69, v127
    v_dot2_f32_bf16 v120, v42, v42, v120
    v_dot2_f32_bf16 v121, v46, v46, v121
    v_dot2_f32_bf16 v122, v50, v50, v122
    v_dot2_f32_bf16 v123, v54, v54, v123
    v_dot2_f32_bf16 v124, v58, v58, v124
    v_dot2_f32_bf16 v125, v62, v62, v125
    v_dot2_f32_bf16 v126, v66, v66, v126
    v_dot2_f32_bf16 v127, v70, v70, v127
    v_dot2_f32_bf16 v120, v43, v43, v120
    v_dot2_f32_bf16 v121, v47, v47, v121
    v_dot2_f32_bf16 v122, v51, v51, v122
    v_dot2_f32_bf16 v123, v55, v55, v123
    v_dot2_f32_bf16 v124, v59, v59, v124
    v_dot2_f32_bf16 v125, v63, v63, v125
    v_dot2_f32_bf16 v126, v67, v67, v126
    v_dot2_f32_bf16 v127, v71, v71, v127
    s_nop 3
    v_add_f32_dpp v128, v120, v120 quad_perm:[1,0,3,2] row_mask:0xf bank_mask:0xf
    v_add_f32_dpp v129, v121, v121 quad_perm:[1,0,3,2] row_mask:0xf bank_mask:0xf
    v_add_f32_dpp v130, v122, v122 quad_perm:[1,0,3,2] row_mask:0xf bank_mask:0xf
    v_add_f32_dpp v131, v123, v123 quad_perm:[1,0,3,2] row_mask:0xf bank_mask:0xf
    v_add_f32_dpp v132, v124, v124 quad_perm:[1,0,3,2] row_mask:0xf bank_mask:0xf
    v_add_f32_dpp v133, v125, v125 quad_perm:[1,0,3,2] row_mask:0xf bank_mask:0xf
    v_add_f32_dpp v134, v126, v126 quad_perm:[1,0,3,2] row_mask:0xf bank_mask:0xf
    v_add_f32_dpp v135, v127, v127 quad_perm:[1,0,3,2] row_mask:0xf bank_mask:0xf
    v_max3_f32 v120, v128, v129, v130
    v_max3_f32 v121, v131, v132, v133
    v_max3_f32 v120, v120, v134, v135
    v_max_f32 v120, v120, v121
    s_nop 1
    v_max_f32_dpp v120, v120, v120 row_shr:1 row_mask:0xf bank_mask:0xf
    s_nop 1
    v_max_f32_dpp v120, v120, v120 row_shr:2 row_mask:0xf bank_mask:0xf
    s_nop 1
    v_max_f32_dpp v120, v120, v120 row_shr:4 row_mask:0xf bank_mask:0xf
    s_nop 1
    v_max_f32_dpp v120, v120, v120 row_shr:8 row_mask:0xf bank_mask:0xf
    s_nop 1
    v_max_f32_dpp v120, v120, v120 row_bcast:15 row_mask:0xa bank_mask:0xf
    s_nop 1
    v_max_f32_dpp v120, v120, v120 row_bcast:31 row_mask:0xc bank_mask:0xf
    v_cmp_eq_u32 vcc, 63, v1
    s_and_saveexec_b64 s[14:15], vcc
    ds_write_b32 v17, v120
    s_mov_b64 exec, s[14:15]
    v_lshlrev_b32 v11, 5, v2
    v_lshl_add_u32 v11, v3, 4, v11
    v_bfe_u32 v14, v0, 2, 2
    v_lshl_add_u32 v14, v3, 2, v14
    v_lshlrev_b32 v14, 5, v14
    v_and_b32 v15, 3, v0
    v_lshl_add_u32 v14, v15, 3, v14
    v_add_u32 v14, 65536, v14
    v_and_b32 v15, 15, v0
    v_lshlrev_b32 v15, 3, v15
    v_add_u32 v15, 131072, v15
    v_bfe_u32 v16, v0, 4, 1
    v_cmp_eq_u32 vcc, 1, v16
    v_mov_b32 v19, 4096
    v_mov_b32 v20, 0
    s_nop 1
    v_cndmask_b32 v12, v14, v15, vcc
    v_cndmask_b32 v10, v19, v20, vcc
    s_waitcnt vmcnt(8)
    v_dot2_f32_bf16 v19, v4, v4, 0
    v_dot2_f32_bf16 v19, v5, v5, v19
    v_dot2_f32_bf16 v19, v6, v6, v19
    v_dot2_f32_bf16 v19, v7, v7, v19
    s_nop 3
    v_mov_b32 v20, v19
    s_nop 1
    v_permlane32_swap_b32 v19, v20
    s_nop 1
    v_add_f32 v19, v19, v20
    s_waitcnt vmcnt(0) lgkmcnt(0)
    s_barrier
    v_mov_b32 v17, 139264
    ds_read_b128 v[120:123], v17
    ds_read_b128 v[124:127], v17 offset:16
    s_cmp_lt_u32 s5, 4
    s_cbranch_scc1 K2_NOPRIO
    s_setprio 1
K2_NOPRIO:
    s_waitcnt lgkmcnt(0)
    v_max3_f32 v20, v120, v121, v122
    v_max3_f32 v20, v20, v123, v124
    v_max3_f32 v20, v20, v125, v126
    v_max_f32 v20, v20, v127
    v_mul_f32 v19, v19, v20
    v_sqrt_f32 v19, v19
    s_nop 0
    v_mul_f32 v19, 0xbf802000, v19
    v_mov_b32 v104, v19
    v_mov_b32 v105, v19
    v_mov_b32 v106, v19
    v_mov_b32 v107, v19
    v_mov_b32 v108, v19
    v_mov_b32 v109, v19
    v_mov_b32 v110, v19
    v_mov_b32 v111, v19
    v_mov_b32 v112, v19
    v_mov_b32 v113, v19
    v_mov_b32 v114, v19
    v_mov_b32 v115, v19
    v_mov_b32 v116, v19
    v_mov_b32 v117, v19
    v_mov_b32 v118, v19
    v_mov_b32 v119, v19
    s_mov_b32 s17, 0
    s_mov_b32 s18, 16
K2_P2_ENTRY:
    v_mov_b32 v8, v11
    v_mov_b32 v9, v12
    ds_read_b128 v[24:27], v8 offset:0
    ds_read_b128 v[28:31], v8 offset:1024
    ds_read_b128 v[32:35], v8 offset:2048
    ds_read_b64_tr_b16 v[136:137], v9 offset:0
    ds_read_b64_tr_b16 v[138:139], v9 offset:256
    ds_read_b64_tr_b16 v[140:141], v9 offset:512
    ds_read_b64_tr_b16 v[142:143], v9 offset:768
    s_waitcnt lgkmcnt(5)
    v_mfma_f32_32x32x16_bf16 v[40:55], v[24:27], v[4:7], v[104:119]
    v_mfma_f32_32x32x16_bf16 v[56:71], v[28:31], v[4:7], v[104:119]
    v_mov_b32 v152, 0
    v_mov_b32 v153, 0
    v_mov_b32 v154, 0
    v_mov_b32 v155, 0
    v_mov_b32 v156, 0
    v_mov_b32 v157, 0
    v_mov_b32 v158, 0
    v_mov_b32 v159, 0
    v_mov_b32 v160, 0
    v_mov_b32 v161, 0
    v_mov_b32 v162, 0
    v_mov_b32 v163, 0
    v_mov_b32 v164, 0
    v_mov_b32 v165, 0
    v_mov_b32 v166, 0
    v_mov_b32 v167, 0
    s_mov_b32 s16, s18
K2_P2:
    ds_read_b128 v[36:39], v8 offset:3072
    ds_read_b64_tr_b16 v[144:145], v9 offset:1024
    ds_read_b64_tr_b16 v[146:147], v9 offset:1280
    ds_read_b64_tr_b16 v[148:149], v9 offset:1536
    ds_read_b64_tr_b16 v[150:151], v9 offset:1792
    s_waitcnt lgkmcnt(5)
    v_mfma_f32_32x32x16_bf16 v[72:87], v[32:35], v[4:7], v[104:119]
    v_exp_f32 v40, v40
    v_exp_f32 v41, v41
    v_exp_f32 v42, v42
    v_exp_f32 v43, v43
    v_exp_f32 v44, v44
    v_exp_f32 v45, v45
    v_exp_f32 v46, v46
    v_exp_f32 v47, v47
    v_exp_f32 v48, v48
    v_exp_f32 v49, v49
    v_exp_f32 v50, v50
    v_exp_f32 v51, v51
    v_exp_f32 v52, v52
    v_exp_f32 v53, v53
    v_exp_f32 v54, v54
    v_exp_f32 v55, v55
    v_cvt_pk_bf16_f32 v120, v40, v41
    v_cvt_pk_bf16_f32 v121, v42, v43
    v_cvt_pk_bf16_f32 v122, v44, v45
    v_cvt_pk_bf16_f32 v123, v46, v47
    v_cvt_pk_bf16_f32 v124, v48, v49
    v_cvt_pk_bf16_f32 v125, v50, v51
    v_cvt_pk_bf16_f32 v126, v52, v53
    v_cvt_pk_bf16_f32 v127, v54, v55
    s_nop 1
    v_mfma_f32_32x32x16_bf16 v[152:167], v[136:139], v[120:123], v[152:167]
    v_mfma_f32_32x32x16_bf16 v[152:167], v[140:143], v[124:127], v[152:167]
    ds_read_b128 v[24:27], v8 offset:4096
    ds_read_b64_tr_b16 v[136:137], v9 offset:2048
    ds_read_b64_tr_b16 v[138:139], v9 offset:2304
    ds_read_b64_tr_b16 v[140:141], v9 offset:2560
    ds_read_b64_tr_b16 v[142:143], v9 offset:2816
    s_waitcnt lgkmcnt(5)
    v_mfma_f32_32x32x16_bf16 v[88:103], v[36:39], v[4:7], v[104:119]
    v_exp_f32 v56, v56
    v_exp_f32 v57, v57
    v_exp_f32 v58, v58
    v_exp_f32 v59, v59
    v_exp_f32 v60, v60
    v_exp_f32 v61, v61
    v_exp_f32 v62, v62
    v_exp_f32 v63, v63
    v_exp_f32 v64, v64
    v_exp_f32 v65, v65
    v_exp_f32 v66, v66
    v_exp_f32 v67, v67
    v_exp_f32 v68, v68
    v_exp_f32 v69, v69
    v_exp_f32 v70, v70
    v_exp_f32 v71, v71
    v_cvt_pk_bf16_f32 v128, v56, v57
    v_cvt_pk_bf16_f32 v129, v58, v59
    v_cvt_pk_bf16_f32 v130, v60, v61
    v_cvt_pk_bf16_f32 v131, v62, v63
    v_cvt_pk_bf16_f32 v132, v64, v65
    v_cvt_pk_bf16_f32 v133, v66, v67
    v_cvt_pk_bf16_f32 v134, v68, v69
    v_cvt_pk_bf16_f32 v135, v70, v71
    s_nop 1
    v_mfma_f32_32x32x16_bf16 v[152:167], v[144:147], v[128:131], v[152:167]
    v_mfma_f32_32x32x16_bf16 v[152:167], v[148:151], v[132:135], v[152:167]
    ds_read_b128 v[28:31], v8 offset:5120
    ds_read_b64_tr_b16 v[144:145], v9 offset:3072
    ds_read_b64_tr_b16 v[146:147], v9 offset:3328
    ds_read_b64_tr_b16 v[148:149], v9 offset:3584
    ds_read_b64_tr_b16 v[150:151], v9 offset:3840
    s_waitcnt lgkmcnt(5)
    v_mfma_f32_32x32x16_bf16 v[40:55], v[24:27], v[4:7], v[104:119]
    v_exp_f32 v72, v72
    v_exp_f32 v73, v73
    v_exp_f32 v74, v74
    v_exp_f32 v75, v75
    v_exp_f32 v76, v76
    v_exp_f32 v77, v77
    v_exp_f32 v78, v78
    v_exp_f32 v79, v79
    v_exp_f32 v80, v80
    v_exp_f32 v81, v81
    v_exp_f32 v82, v82
    v_exp_f32 v83, v83
    v_exp_f32 v84, v84
    v_exp_f32 v85, v85
    v_exp_f32 v86, v86
    v_exp_f32 v87, v87
    v_cvt_pk_bf16_f32 v120, v72, v73
    v_cvt_pk_bf16_f32 v121, v74, v75
    v_cvt_pk_bf16_f32 v122, v76, v77
    v_cvt_pk_bf16_f32 v123, v78, v79
    v_cvt_pk_bf16_f32 v124, v80, v81
    v_cvt_pk_bf16_f32 v125, v82, v83
    v_cvt_pk_bf16_f32 v126, v84, v85
    v_cvt_pk_bf16_f32 v127, v86, v87
    s_nop 1
    v_mfma_f32_32x32x16_bf16 v[152:167], v[136:139], v[120:123], v[152:167]
    v_mfma_f32_32x32x16_bf16 v[152:167], v[140:143], v[124:127], v[152:167]
    ds_read_b128 v[32:35], v8 offset:6144
    ds_read_b64_tr_b16 v[136:137], v9 offset:4096
    ds_read_b64_tr_b16 v[138:139], v9 offset:4352
    ds_read_b64_tr_b16 v[140:141], v9 offset:4608
    ds_read_b64_tr_b16 v[142:143], v9 offset:4864
    s_waitcnt lgkmcnt(5)
    v_mfma_f32_32x32x16_bf16 v[56:71], v[28:31], v[4:7], v[104:119]
    v_exp_f32 v88, v88
    v_exp_f32 v89, v89
    v_exp_f32 v90, v90
    v_exp_f32 v91, v91
    v_exp_f32 v92, v92
    v_exp_f32 v93, v93
    v_exp_f32 v94, v94
    v_exp_f32 v95, v95
    v_exp_f32 v96, v96
    v_exp_f32 v97, v97
    v_exp_f32 v98, v98
    v_exp_f32 v99, v99
    v_exp_f32 v100, v100
    v_exp_f32 v101, v101
    v_exp_f32 v102, v102
    v_exp_f32 v103, v103
    v_cvt_pk_bf16_f32 v128, v88, v89
    v_cvt_pk_bf16_f32 v129, v90, v91
    v_cvt_pk_bf16_f32 v130, v92, v93
    v_cvt_pk_bf16_f32 v131, v94, v95
    v_cvt_pk_bf16_f32 v132, v96, v97
    v_cvt_pk_bf16_f32 v133, v98, v99
    v_cvt_pk_bf16_f32 v134, v100, v101
    v_cvt_pk_bf16_f32 v135, v102, v103
    s_nop 1
    v_mfma_f32_32x32x16_bf16 v[152:167], v[144:147], v[128:131], v[152:167]
    v_mfma_f32_32x32x16_bf16 v[152:167], v[148:151], v[132:135], v[152:167]
    v_add_u32 v8, 4096, v8
    v_add_u32 v9, v10, v9
    s_sub_u32 s16, s16, 1
    s_cmp_lg_u32 s16, 5
    s_cbranch_scc1 K2_P2B
    s_setprio 0
K2_P2B:
    s_cmp_lg_u32 s16, 0
    s_cbranch_scc1 K2_P2
    s_waitcnt lgkmcnt(0)
    s_nop 15
    s_nop 7
    s_cmp_lg_u32 s17, 0
    s_cbranch_scc1 K2_FIN
    v_mov_b32 v13, 0x12800000
    v_cmp_nge_f32 vcc, v160, v13
    s_nop 4
    s_cmp_eq_u64 vcc, 0
    s_cbranch_scc1 K2_FIN
    s_mov_b32 s17, 1
    s_mov_b32 s18, 16
    v_mov_b32 v8, v11
    v_mov_b32 v19, 0xff800000
    v_mov_b32 v20, 0xff800000
    ds_read_b128 v[24:27], v8 offset:0
    ds_read_b128 v[28:31], v8 offset:1024
    ds_read_b128 v[32:35], v8 offset:2048
    s_waitcnt lgkmcnt(1)
    v_mfma_f32_32x32x16_bf16 v[40:55], v[24:27], v[4:7], 0
    v_mfma_f32_32x32x16_bf16 v[56:71], v[28:31], v[4:7], 0
    s_mov_b32 s16, 16
K2_P1:
    ds_read_b128 v[36:39], v8 offset:3072
    s_waitcnt lgkmcnt(1)
    v_mfma_f32_32x32x16_bf16 v[72:87], v[32:35], v[4:7], 0
    v_max3_f32 v19, v40, v41, v19
    v_max3_f32 v20, v42, v43, v20
    v_max3_f32 v19, v44, v45, v19
    v_max3_f32 v20, v46, v47, v20
    v_max3_f32 v19, v48, v49, v19
    v_max3_f32 v20, v50, v51, v20
    v_max3_f32 v19, v52, v53, v19
    v_max3_f32 v20, v54, v55, v20
    ds_read_b128 v[24:27], v8 offset:4096
    s_waitcnt lgkmcnt(1)
    v_mfma_f32_32x32x16_bf16 v[88:103], v[36:39], v[4:7], 0
    v_max3_f32 v19, v56, v57, v19
    v_max3_f32 v20, v58, v59, v20
    v_max3_f32 v19, v60, v61, v19
    v_max3_f32 v20, v62, v63, v20
    v_max3_f32 v19, v64, v65, v19
    v_max3_f32 v20, v66, v67, v20
    v_max3_f32 v19, v68, v69, v19
    v_max3_f32 v20, v70, v71, v20
    ds_read_b128 v[28:31], v8 offset:5120
    s_waitcnt lgkmcnt(1)
    v_mfma_f32_32x32x16_bf16 v[40:55], v[24:27], v[4:7], 0
    v_max3_f32 v19, v72, v73, v19
    v_max3_f32 v20, v74, v75, v20
    v_max3_f32 v19, v76, v77, v19
    v_max3_f32 v20, v78, v79, v20
    v_max3_f32 v19, v80, v81, v19
    v_max3_f32 v20, v82, v83, v20
    v_max3_f32 v19, v84, v85, v19
    v_max3_f32 v20, v86, v87, v20
    ds_read_b128 v[32:35], v8 offset:6144
    s_waitcnt lgkmcnt(1)
    v_mfma_f32_32x32x16_bf16 v[56:71], v[28:31], v[4:7], 0
    v_max3_f32 v19, v88, v89, v19
    v_max3_f32 v20, v90, v91, v20
    v_max3_f32 v19, v92, v93, v19
    v_max3_f32 v20, v94, v95, v20
    v_max3_f32 v19, v96, v97, v19
    v_max3_f32 v20, v98, v99, v20
    v_max3_f32 v19, v100, v101, v19
    v_max3_f32 v20, v102, v103, v20
    v_add_u32 v8, 4096, v8
    s_sub_u32 s16, s16, 1
    s_cmp_lg_u32 s16, 0
    s_cbranch_scc1 K2_P1
    v_max_f32 v19, v19, v20
    s_nop 1
    v_mov_b32 v20, v19
    s_nop 1
    v_permlane32_swap_b32 v19, v20
    s_nop 1
    v_max_f32 v19, v19, v20
    s_waitcnt lgkmcnt(0)
    s_nop 15
    v_sub_f32 v104, 0, v19
    v_sub_f32 v105, 0, v19
    v_sub_f32 v106, 0, v19
    v_sub_f32 v107, 0, v19
    v_sub_f32 v108, 0, v19
    v_sub_f32 v109, 0, v19
    v_sub_f32 v110, 0, v19
    v_sub_f32 v111, 0, v19
    v_sub_f32 v112, 0, v19
    v_sub_f32 v113, 0, v19
    v_sub_f32 v114, 0, v19
    v_sub_f32 v115, 0, v19
    v_sub_f32 v116, 0, v19
    v_sub_f32 v117, 0, v19
    v_sub_f32 v118, 0, v19
    v_sub_f32 v119, 0, v19
    s_nop 7
    s_branch K2_P2_ENTRY
K2_FIN:
    v_rcp_f32 v13, v160
    s_nop 1
    v_mul_f32 v152, v152, v13
    v_mul_f32 v153, v153, v13
    v_mul_f32 v154, v154, v13
    v_mul_f32 v155, v155, v13
    v_mul_f32 v156, v156, v13
    v_mul_f32 v157, v157, v13
    v_mul_f32 v158, v158, v13
    v_mul_f32 v159, v159, v13
    v_cvt_pk_bf16_f32 v120, v152, v153
    v_cvt_pk_bf16_f32 v121, v154, v155
    v_cvt_pk_bf16_f32 v122, v156, v157
    v_cvt_pk_bf16_f32 v123, v158, v159
    v_lshlrev_b32 v14, 4, v1
    s_lshr_b32 s7, s12, 5
    s_lshl_b32 s7, s7, 5
    s_add_u32 s7, s7, s3
    s_lshl_b32 s7, s7, 10
    s_add_u32 s7, s7, 16777216
    v_permlane32_swap_b32 v120, v122
    v_permlane32_swap_b32 v121, v123
    s_nop 1
    buffer_store_dwordx4 v[120:123], v14, s[8:11], s7 offen sc1
    v_mov_b32 v15, 139264
    v_mov_b32 v16, 1
    s_waitcnt vmcnt(0)
    v_cmp_eq_u32 vcc, 0, v1
    s_and_saveexec_b64 s[14:15], vcc
    ds_add_rtn_u32 v17, v15, v16 offset:64
    s_waitcnt lgkmcnt(0)
    v_readfirstlane_b32 s7, v17
    s_cmp_lg_u32 s7, 7
    s_cbranch_scc1 K2_NOFLAG
    s_lshl_b32 s7, s4, 7
    s_lshl_b32 s13, s3, 2
    s_add_u32 s7, s7, s13
    s_add_u32 s7, s7, 15761408
    v_mov_b32 v15, 0
    buffer_store_dword v16, v15, s[8:11], s7 offen sc1
K2_NOFLAG:
    s_mov_b64 exec, s[14:15]
    s_endpgm
K2_FFN:
    s_barrier
    s_sub_u32 s5, s5, 8
    s_and_b32 s3, s2, 7
    s_lshl_b32 s3, s3, 2
    s_lshr_b32 s4, s2, 6
    s_add_u32 s3, s3, s4
    s_lshr_b32 s4, s2, 3
    s_and_b32 s4, s4, 7
    s_lshl_b32 s3, s3, 6
    s_and_b32 s6, s5, 1
    s_lshl_b32 s6, s6, 5
    s_add_u32 s3, s3, s6
    s_lshl_b32 s4, s4, 6
    s_lshr_b32 s6, s5, 1
    s_lshl_b32 s6, s6, 5
    s_add_u32 s4, s4, s6
    s_lshr_b32 s6, s4, 5
    s_mul_i32 s6, s6, 88064
    s_add_u32 s6, s6, 12582912
    v_lshlrev_b32 v4, 4, v1
    v_add_u32 v4, s6, v4
    v_add_u32 v7, s3, v2
    s_lshr_b32 s6, s3, 5
    s_mul_i32 s6, s6, 88064
    s_add_u32 s6, s6, 6291456
    v_lshlrev_b32 v5, 4, v1
    v_add_u32 v5, s6, v5
    v_lshlrev_b32 v6, 2, v7
    s_mov_b32 s7, 15728640
    buffer_load_dword v8, v6, s[8:11], s7 offen
    s_mov_b32 s7, 15736832
    buffer_load_dword v6, v6, s[8:11], s7 offen
    s_mov_b32 s40, 0
    buffer_load_dwordx4 v[52:55], v4, s[8:11], s40 offen offset:0
    buffer_load_dwordx4 v[56:59], v5, s[8:11], s40 offen offset:0
    buffer_load_dwordx4 v[60:63], v4, s[8:11], s40 offen offset:1024
    buffer_load_dwordx4 v[64:67], v5, s[8:11], s40 offen offset:1024
    buffer_load_dwordx4 v[68:71], v4, s[8:11], s40 offen offset:2048
    buffer_load_dwordx4 v[72:75], v5, s[8:11], s40 offen offset:2048
    buffer_load_dwordx4 v[76:79], v4, s[8:11], s40 offen offset:3072
    buffer_load_dwordx4 v[80:83], v5, s[8:11], s40 offen offset:3072
    s_mov_b32 s40, 4096
    buffer_load_dwordx4 v[84:87], v4, s[8:11], s40 offen offset:0
    buffer_load_dwordx4 v[88:91], v5, s[8:11], s40 offen offset:0
    buffer_load_dwordx4 v[92:95], v4, s[8:11], s40 offen offset:1024
    buffer_load_dwordx4 v[96:99], v5, s[8:11], s40 offen offset:1024
    buffer_load_dwordx4 v[100:103], v4, s[8:11], s40 offen offset:2048
    buffer_load_dwordx4 v[104:107], v5, s[8:11], s40 offen offset:2048
    buffer_load_dwordx4 v[108:111], v4, s[8:11], s40 offen offset:3072
    buffer_load_dwordx4 v[112:115], v5, s[8:11], s40 offen offset:3072
    s_waitcnt vmcnt(14)
    v_mfma_f32_32x32x16_bf16 v[12:27], v[52:55], v[56:59], 0
    s_mov_b32 s40, 8192
    buffer_load_dwordx4 v[52:55], v4, s[8:11], s40 offen offset:0
    buffer_load_dwordx4 v[56:59], v5, s[8:11], s40 offen offset:0
    s_waitcnt vmcnt(14)
    v_mfma_f32_32x32x16_bf16 v[12:27], v[60:63], v[64:67], v[12:27]
    buffer_load_dwordx4 v[60:63], v4, s[8:11], s40 offen offset:1024
    buffer_load_dwordx4 v[64:67], v5, s[8:11], s40 offen offset:1024
    s_waitcnt vmcnt(14)
    v_mfma_f32_32x32x16_bf16 v[12:27], v[68:71], v[72:75], v[12:27]
    buffer_load_dwordx4 v[68:71], v4, s[8:11], s40 offen offset:2048
    buffer_load_dwordx4 v[72:75], v5, s[8:11], s40 offen offset:2048
    s_waitcnt vmcnt(14)
    v_mfma_f32_32x32x16_bf16 v[12:27], v[76:79], v[80:83], v[12:27]
    buffer_load_dwordx4 v[76:79], v4, s[8:11], s40 offen offset:3072
    buffer_load_dwordx4 v[80:83], v5, s[8:11], s40 offen offset:3072
    s_waitcnt vmcnt(14)
    v_mfma_f32_32x32x16_bf16 v[12:27], v[84:87], v[88:91], v[12:27]
    s_mov_b32 s40, 12288
    buffer_load_dwordx4 v[84:87], v4, s[8:11], s40 offen offset:0
    buffer_load_dwordx4 v[88:91], v5, s[8:11], s40 offen offset:0
    s_waitcnt vmcnt(14)
    v_mfma_f32_32x32x16_bf16 v[12:27], v[92:95], v[96:99], v[12:27]
    buffer_load_dwordx4 v[92:95], v4, s[8:11], s40 offen offset:1024
    buffer_load_dwordx4 v[96:99], v5, s[8:11], s40 offen offset:1024
    s_waitcnt vmcnt(14)
    v_mfma_f32_32x32x16_bf16 v[12:27], v[100:103], v[104:107], v[12:27]
    buffer_load_dwordx4 v[100:103], v4, s[8:11], s40 offen offset:2048
    buffer_load_dwordx4 v[104:107], v5, s[8:11], s40 offen offset:2048
    s_waitcnt vmcnt(14)
    v_mfma_f32_32x32x16_bf16 v[12:27], v[108:111], v[112:115], v[12:27]
    buffer_load_dwordx4 v[108:111], v4, s[8:11], s40 offen offset:3072
    buffer_load_dwordx4 v[112:115], v5, s[8:11], s40 offen offset:3072
    s_waitcnt vmcnt(14)
    v_mfma_f32_32x32x16_bf16 v[12:27], v[52:55], v[56:59], v[12:27]
    s_mov_b32 s40, 16384
    buffer_load_dwordx4 v[52:55], v4, s[8:11], s40 offen offset:0
    buffer_load_dwordx4 v[56:59], v5, s[8:11], s40 offen offset:0
    s_waitcnt vmcnt(14)
    v_mfma_f32_32x32x16_bf16 v[12:27], v[60:63], v[64:67], v[12:27]
    buffer_load_dwordx4 v[60:63], v4, s[8:11], s40 offen offset:1024
    buffer_load_dwordx4 v[64:67], v5, s[8:11], s40 offen offset:1024
    s_waitcnt vmcnt(14)
    v_mfma_f32_32x32x16_bf16 v[12:27], v[68:71], v[72:75], v[12:27]
    buffer_load_dwordx4 v[68:71], v4, s[8:11], s40 offen offset:2048
    buffer_load_dwordx4 v[72:75], v5, s[8:11], s40 offen offset:2048
    s_waitcnt vmcnt(14)
    v_mfma_f32_32x32x16_bf16 v[12:27], v[76:79], v[80:83], v[12:27]
    buffer_load_dwordx4 v[76:79], v4, s[8:11], s40 offen offset:3072
    buffer_load_dwordx4 v[80:83], v5, s[8:11], s40 offen offset:3072
    s_waitcnt vmcnt(14)
    v_mfma_f32_32x32x16_bf16 v[12:27], v[84:87], v[88:91], v[12:27]
    s_mov_b32 s40, 20480
    buffer_load_dwordx4 v[84:87], v4, s[8:11], s40 offen offset:0
    buffer_load_dwordx4 v[88:91], v5, s[8:11], s40 offen offset:0
    s_waitcnt vmcnt(14)
    v_mfma_f32_32x32x16_bf16 v[12:27], v[92:95], v[96:99], v[12:27]
    buffer_load_dwordx4 v[92:95], v4, s[8:11], s40 offen offset:1024
    buffer_load_dwordx4 v[96:99], v5, s[8:11], s40 offen offset:1024
    s_waitcnt vmcnt(14)
    v_mfma_f32_32x32x16_bf16 v[12:27], v[100:103], v[104:107], v[12:27]
    buffer_load_dwordx4 v[100:103], v4, s[8:11], s40 offen offset:2048
    buffer_load_dwordx4 v[104:107], v5, s[8:11], s40 offen offset:2048
    s_waitcnt vmcnt(14)
    v_mfma_f32_32x32x16_bf16 v[12:27], v[108:111], v[112:115], v[12:27]
    buffer_load_dwordx4 v[108:111], v4, s[8:11], s40 offen offset:3072
    buffer_load_dwordx4 v[112:115], v5, s[8:11], s40 offen offset:3072
    s_waitcnt vmcnt(14)
    v_mfma_f32_32x32x16_bf16 v[12:27], v[52:55], v[56:59], v[12:27]
    s_mov_b32 s40, 24576
    buffer_load_dwordx4 v[52:55], v4, s[8:11], s40 offen offset:0
    buffer_load_dwordx4 v[56:59], v5, s[8:11], s40 offen offset:0
    s_waitcnt vmcnt(14)
    v_mfma_f32_32x32x16_bf16 v[12:27], v[60:63], v[64:67], v[12:27]
    buffer_load_dwordx4 v[60:63], v4, s[8:11], s40 offen offset:1024
    buffer_load_dwordx4 v[64:67], v5, s[8:11], s40 offen offset:1024
    s_waitcnt vmcnt(14)
    v_mfma_f32_32x32x16_bf16 v[12:27], v[68:71], v[72:75], v[12:27]
    buffer_load_dwordx4 v[68:71], v4, s[8:11], s40 offen offset:2048
    buffer_load_dwordx4 v[72:75], v5, s[8:11], s40 offen offset:2048
    s_waitcnt vmcnt(14)
    v_mfma_f32_32x32x16_bf16 v[12:27], v[76:79], v[80:83], v[12:27]
    buffer_load_dwordx4 v[76:79], v4, s[8:11], s40 offen offset:3072
    buffer_load_dwordx4 v[80:83], v5, s[8:11], s40 offen offset:3072
    s_waitcnt vmcnt(14)
    v_mfma_f32_32x32x16_bf16 v[12:27], v[84:87], v[88:91], v[12:27]
    s_mov_b32 s40, 28672
    buffer_load_dwordx4 v[84:87], v4, s[8:11], s40 offen offset:0
    buffer_load_dwordx4 v[88:91], v5, s[8:11], s40 offen offset:0
    s_waitcnt vmcnt(14)
    v_mfma_f32_32x32x16_bf16 v[12:27], v[92:95], v[96:99], v[12:27]
    buffer_load_dwordx4 v[92:95], v4, s[8:11], s40 offen offset:1024
    buffer_load_dwordx4 v[96:99], v5, s[8:11], s40 offen offset:1024
    s_waitcnt vmcnt(14)
    v_mfma_f32_32x32x16_bf16 v[12:27], v[100:103], v[104:107], v[12:27]
    buffer_load_dwordx4 v[100:103], v4, s[8:11], s40 offen offset:2048
    buffer_load_dwordx4 v[104:107], v5, s[8:11], s40 offen offset:2048
    s_waitcnt vmcnt(14)
    v_mfma_f32_32x32x16_bf16 v[12:27], v[108:111], v[112:115], v[12:27]
    buffer_load_dwordx4 v[108:111], v4, s[8:11], s40 offen offset:3072
    buffer_load_dwordx4 v[112:115], v5, s[8:11], s40 offen offset:3072
    s_waitcnt vmcnt(14)
    v_mfma_f32_32x32x16_bf16 v[12:27], v[52:55], v[56:59], v[12:27]
    s_mov_b32 s40, 32768
    buffer_load_dwordx4 v[52:55], v4, s[8:11], s40 offen offset:0
    buffer_load_dwordx4 v[56:59], v5, s[8:11], s40 offen offset:0
    s_waitcnt vmcnt(14)
    v_mfma_f32_32x32x16_bf16 v[12:27], v[60:63], v[64:67], v[12:27]
    buffer_load_dwordx4 v[60:63], v4, s[8:11], s40 offen offset:1024
    buffer_load_dwordx4 v[64:67], v5, s[8:11], s40 offen offset:1024
    s_waitcnt vmcnt(14)
    v_mfma_f32_32x32x16_bf16 v[12:27], v[68:71], v[72:75], v[12:27]
    buffer_load_dwordx4 v[68:71], v4, s[8:11], s40 offen offset:2048
    buffer_load_dwordx4 v[72:75], v5, s[8:11], s40 offen offset:2048
    s_waitcnt vmcnt(14)
    v_mfma_f32_32x32x16_bf16 v[12:27], v[76:79], v[80:83], v[12:27]
    buffer_load_dwordx4 v[76:79], v4, s[8:11], s40 offen offset:3072
    buffer_load_dwordx4 v[80:83], v5, s[8:11], s40 offen offset:3072
    s_waitcnt vmcnt(14)
    v_mfma_f32_32x32x16_bf16 v[12:27], v[84:87], v[88:91], v[12:27]
    s_mov_b32 s40, 36864
    buffer_load_dwordx4 v[84:87], v4, s[8:11], s40 offen offset:0
    buffer_load_dwordx4 v[88:91], v5, s[8:11], s40 offen offset:0
    s_waitcnt vmcnt(14)
    v_mfma_f32_32x32x16_bf16 v[12:27], v[92:95], v[96:99], v[12:27]
    buffer_load_dwordx4 v[92:95], v4, s[8:11], s40 offen offset:1024
    buffer_load_dwordx4 v[96:99], v5, s[8:11], s40 offen offset:1024
    s_waitcnt vmcnt(14)
    v_mfma_f32_32x32x16_bf16 v[12:27], v[100:103], v[104:107], v[12:27]
    buffer_load_dwordx4 v[100:103], v4, s[8:11], s40 offen offset:2048
    buffer_load_dwordx4 v[104:107], v5, s[8:11], s40 offen offset:2048
    s_waitcnt vmcnt(14)
    v_mfma_f32_32x32x16_bf16 v[12:27], v[108:111], v[112:115], v[12:27]
    buffer_load_dwordx4 v[108:111], v4, s[8:11], s40 offen offset:3072
    buffer_load_dwordx4 v[112:115], v5, s[8:11], s40 offen offset:3072
    s_waitcnt vmcnt(14)
    v_mfma_f32_32x32x16_bf16 v[12:27], v[52:55], v[56:59], v[12:27]
    s_mov_b32 s40, 40960
    buffer_load_dwordx4 v[52:55], v4, s[8:11], s40 offen offset:0
    buffer_load_dwordx4 v[56:59], v5, s[8:11], s40 offen offset:0
    s_waitcnt vmcnt(14)
    v_mfma_f32_32x32x16_bf16 v[12:27], v[60:63], v[64:67], v[12:27]
    buffer_load_dwordx4 v[60:63], v4, s[8:11], s40 offen offset:1024
    buffer_load_dwordx4 v[64:67], v5, s[8:11], s40 offen offset:1024
    s_waitcnt vmcnt(14)
    v_mfma_f32_32x32x16_bf16 v[12:27], v[68:71], v[72:75], v[12:27]
    buffer_load_dwordx4 v[68:71], v4, s[8:11], s40 offen offset:2048
    buffer_load_dwordx4 v[72:75], v5, s[8:11], s40 offen offset:2048
    s_waitcnt vmcnt(14)
    v_mfma_f32_32x32x16_bf16 v[12:27], v[76:79], v[80:83], v[12:27]
    buffer_load_dwordx4 v[76:79], v4, s[8:11], s40 offen offset:3072
    buffer_load_dwordx4 v[80:83], v5, s[8:11], s40 offen offset:3072
    s_waitcnt vmcnt(14)
    v_mfma_f32_32x32x16_bf16 v[12:27], v[84:87], v[88:91], v[12:27]
    s_mov_b32 s40, 45056
    buffer_load_dwordx4 v[84:87], v4, s[8:11], s40 offen offset:0
    buffer_load_dwordx4 v[88:91], v5, s[8:11], s40 offen offset:0
    s_waitcnt vmcnt(14)
    v_mfma_f32_32x32x16_bf16 v[12:27], v[92:95], v[96:99], v[12:27]
    buffer_load_dwordx4 v[92:95], v4, s[8:11], s40 offen offset:1024
    buffer_load_dwordx4 v[96:99], v5, s[8:11], s40 offen offset:1024
    s_waitcnt vmcnt(14)
    v_mfma_f32_32x32x16_bf16 v[12:27], v[100:103], v[104:107], v[12:27]
    buffer_load_dwordx4 v[100:103], v4, s[8:11], s40 offen offset:2048
    buffer_load_dwordx4 v[104:107], v5, s[8:11], s40 offen offset:2048
    s_waitcnt vmcnt(14)
    v_mfma_f32_32x32x16_bf16 v[12:27], v[108:111], v[112:115], v[12:27]
    buffer_load_dwordx4 v[108:111], v4, s[8:11], s40 offen offset:3072
    buffer_load_dwordx4 v[112:115], v5, s[8:11], s40 offen offset:3072
    s_waitcnt vmcnt(14)
    v_mfma_f32_32x32x16_bf16 v[12:27], v[52:55], v[56:59], v[12:27]
    s_mov_b32 s40, 49152
    buffer_load_dwordx4 v[52:55], v4, s[8:11], s40 offen offset:0
    buffer_load_dwordx4 v[56:59], v5, s[8:11], s40 offen offset:0
    s_waitcnt vmcnt(14)
    v_mfma_f32_32x32x16_bf16 v[12:27], v[60:63], v[64:67], v[12:27]
    buffer_load_dwordx4 v[60:63], v4, s[8:11], s40 offen offset:1024
    buffer_load_dwordx4 v[64:67], v5, s[8:11], s40 offen offset:1024
    s_waitcnt vmcnt(14)
    v_mfma_f32_32x32x16_bf16 v[12:27], v[68:71], v[72:75], v[12:27]
    buffer_load_dwordx4 v[68:71], v4, s[8:11], s40 offen offset:2048
    buffer_load_dwordx4 v[72:75], v5, s[8:11], s40 offen offset:2048
    s_waitcnt vmcnt(14)
    v_mfma_f32_32x32x16_bf16 v[12:27], v[76:79], v[80:83], v[12:27]
    buffer_load_dwordx4 v[76:79], v4, s[8:11], s40 offen offset:3072
    buffer_load_dwordx4 v[80:83], v5, s[8:11], s40 offen offset:3072
    s_waitcnt vmcnt(14)
    v_mfma_f32_32x32x16_bf16 v[12:27], v[84:87], v[88:91], v[12:27]
    s_mov_b32 s40, 53248
    buffer_load_dwordx4 v[84:87], v4, s[8:11], s40 offen offset:0
    buffer_load_dwordx4 v[88:91], v5, s[8:11], s40 offen offset:0
    s_waitcnt vmcnt(14)
    v_mfma_f32_32x32x16_bf16 v[12:27], v[92:95], v[96:99], v[12:27]
    buffer_load_dwordx4 v[92:95], v4, s[8:11], s40 offen offset:1024
    buffer_load_dwordx4 v[96:99], v5, s[8:11], s40 offen offset:1024
    s_waitcnt vmcnt(14)
    v_mfma_f32_32x32x16_bf16 v[12:27], v[100:103], v[104:107], v[12:27]
    buffer_load_dwordx4 v[100:103], v4, s[8:11], s40 offen offset:2048
    buffer_load_dwordx4 v[104:107], v5, s[8:11], s40 offen offset:2048
    s_waitcnt vmcnt(14)
    v_mfma_f32_32x32x16_bf16 v[12:27], v[108:111], v[112:115], v[12:27]
    buffer_load_dwordx4 v[108:111], v4, s[8:11], s40 offen offset:3072
    buffer_load_dwordx4 v[112:115], v5, s[8:11], s40 offen offset:3072
    s_waitcnt vmcnt(14)
    v_mfma_f32_32x32x16_bf16 v[12:27], v[52:55], v[56:59], v[12:27]
    s_mov_b32 s40, 57344
    buffer_load_dwordx4 v[52:55], v4, s[8:11], s40 offen offset:0
    buffer_load_dwordx4 v[56:59], v5, s[8:11], s40 offen offset:0
    s_waitcnt vmcnt(14)
    v_mfma_f32_32x32x16_bf16 v[12:27], v[60:63], v[64:67], v[12:27]
    buffer_load_dwordx4 v[60:63], v4, s[8:11], s40 offen offset:1024
    buffer_load_dwordx4 v[64:67], v5, s[8:11], s40 offen offset:1024
    s_waitcnt vmcnt(14)
    v_mfma_f32_32x32x16_bf16 v[12:27], v[68:71], v[72:75], v[12:27]
    buffer_load_dwordx4 v[68:71], v4, s[8:11], s40 offen offset:2048
    buffer_load_dwordx4 v[72:75], v5, s[8:11], s40 offen offset:2048
    s_waitcnt vmcnt(14)
    v_mfma_f32_32x32x16_bf16 v[12:27], v[76:79], v[80:83], v[12:27]
    buffer_load_dwordx4 v[76:79], v4, s[8:11], s40 offen offset:3072
    buffer_load_dwordx4 v[80:83], v5, s[8:11], s40 offen offset:3072
    s_waitcnt vmcnt(14)
    v_mfma_f32_32x32x16_bf16 v[12:27], v[84:87], v[88:91], v[12:27]
    s_mov_b32 s40, 61440
    buffer_load_dwordx4 v[84:87], v4, s[8:11], s40 offen offset:0
    buffer_load_dwordx4 v[88:91], v5, s[8:11], s40 offen offset:0
    s_waitcnt vmcnt(14)
    v_mfma_f32_32x32x16_bf16 v[12:27], v[92:95], v[96:99], v[12:27]
    buffer_load_dwordx4 v[92:95], v4, s[8:11], s40 offen offset:1024
    buffer_load_dwordx4 v[96:99], v5, s[8:11], s40 offen offset:1024
    s_waitcnt vmcnt(14)
    v_mfma_f32_32x32x16_bf16 v[12:27], v[100:103], v[104:107], v[12:27]
    buffer_load_dwordx4 v[100:103], v4, s[8:11], s40 offen offset:2048
    buffer_load_dwordx4 v[104:107], v5, s[8:11], s40 offen offset:2048
    s_waitcnt vmcnt(14)
    v_mfma_f32_32x32x16_bf16 v[12:27], v[108:111], v[112:115], v[12:27]
    buffer_load_dwordx4 v[108:111], v4, s[8:11], s40 offen offset:3072
    buffer_load_dwordx4 v[112:115], v5, s[8:11], s40 offen offset:3072
    s_waitcnt vmcnt(14)
    v_mfma_f32_32x32x16_bf16 v[12:27], v[52:55], v[56:59], v[12:27]
    s_mov_b32 s40, 65536
    buffer_load_dwordx4 v[52:55], v4, s[8:11], s40 offen offset:0
    buffer_load_dwordx4 v[56:59], v5, s[8:11], s40 offen offset:0
    s_waitcnt vmcnt(14)
    v_mfma_f32_32x32x16_bf16 v[12:27], v[60:63], v[64:67], v[12:27]
    buffer_load_dwordx4 v[60:63], v4, s[8:11], s40 offen offset:1024
    buffer_load_dwordx4 v[64:67], v5, s[8:11], s40 offen offset:1024
    s_waitcnt vmcnt(14)
    v_mfma_f32_32x32x16_bf16 v[12:27], v[68:71], v[72:75], v[12:27]
    buffer_load_dwordx4 v[68:71], v4, s[8:11], s40 offen offset:2048
    buffer_load_dwordx4 v[72:75], v5, s[8:11], s40 offen offset:2048
    s_waitcnt vmcnt(14)
    v_mfma_f32_32x32x16_bf16 v[12:27], v[76:79], v[80:83], v[12:27]
    buffer_load_dwordx4 v[76:79], v4, s[8:11], s40 offen offset:3072
    buffer_load_dwordx4 v[80:83], v5, s[8:11], s40 offen offset:3072
    s_waitcnt vmcnt(14)
    v_mfma_f32_32x32x16_bf16 v[12:27], v[84:87], v[88:91], v[12:27]
    s_mov_b32 s40, 69632
    buffer_load_dwordx4 v[84:87], v4, s[8:11], s40 offen offset:0
    buffer_load_dwordx4 v[88:91], v5, s[8:11], s40 offen offset:0
    s_waitcnt vmcnt(14)
    v_mfma_f32_32x32x16_bf16 v[12:27], v[92:95], v[96:99], v[12:27]
    buffer_load_dwordx4 v[92:95], v4, s[8:11], s40 offen offset:1024
    buffer_load_dwordx4 v[96:99], v5, s[8:11], s40 offen offset:1024
    s_waitcnt vmcnt(14)
    v_mfma_f32_32x32x16_bf16 v[12:27], v[100:103], v[104:107], v[12:27]
    buffer_load_dwordx4 v[100:103], v4, s[8:11], s40 offen offset:2048
    buffer_load_dwordx4 v[104:107], v5, s[8:11], s40 offen offset:2048
    s_waitcnt vmcnt(14)
    v_mfma_f32_32x32x16_bf16 v[12:27], v[108:111], v[112:115], v[12:27]
    buffer_load_dwordx4 v[108:111], v4, s[8:11], s40 offen offset:3072
    buffer_load_dwordx4 v[112:115], v5, s[8:11], s40 offen offset:3072
    s_waitcnt vmcnt(14)
    v_mfma_f32_32x32x16_bf16 v[12:27], v[52:55], v[56:59], v[12:27]
    s_mov_b32 s40, 73728
    buffer_load_dwordx4 v[52:55], v4, s[8:11], s40 offen offset:0
    buffer_load_dwordx4 v[56:59], v5, s[8:11], s40 offen offset:0
    s_waitcnt vmcnt(14)
    v_mfma_f32_32x32x16_bf16 v[12:27], v[60:63], v[64:67], v[12:27]
    buffer_load_dwordx4 v[60:63], v4, s[8:11], s40 offen offset:1024
    buffer_load_dwordx4 v[64:67], v5, s[8:11], s40 offen offset:1024
    s_waitcnt vmcnt(14)
    v_mfma_f32_32x32x16_bf16 v[12:27], v[68:71], v[72:75], v[12:27]
    buffer_load_dwordx4 v[68:71], v4, s[8:11], s40 offen offset:2048
    buffer_load_dwordx4 v[72:75], v5, s[8:11], s40 offen offset:2048
    s_waitcnt vmcnt(14)
    v_mfma_f32_32x32x16_bf16 v[12:27], v[76:79], v[80:83], v[12:27]
    buffer_load_dwordx4 v[76:79], v4, s[8:11], s40 offen offset:3072
    buffer_load_dwordx4 v[80:83], v5, s[8:11], s40 offen offset:3072
    s_waitcnt vmcnt(14)
    v_mfma_f32_32x32x16_bf16 v[12:27], v[84:87], v[88:91], v[12:27]
    s_mov_b32 s40, 77824
    buffer_load_dwordx4 v[84:87], v4, s[8:11], s40 offen offset:0
    buffer_load_dwordx4 v[88:91], v5, s[8:11], s40 offen offset:0
    s_waitcnt vmcnt(14)
    v_mfma_f32_32x32x16_bf16 v[12:27], v[92:95], v[96:99], v[12:27]
    buffer_load_dwordx4 v[92:95], v4, s[8:11], s40 offen offset:1024
    buffer_load_dwordx4 v[96:99], v5, s[8:11], s40 offen offset:1024
    s_waitcnt vmcnt(14)
    v_mfma_f32_32x32x16_bf16 v[12:27], v[100:103], v[104:107], v[12:27]
    buffer_load_dwordx4 v[100:103], v4, s[8:11], s40 offen offset:2048
    buffer_load_dwordx4 v[104:107], v5, s[8:11], s40 offen offset:2048
    s_waitcnt vmcnt(14)
    v_mfma_f32_32x32x16_bf16 v[12:27], v[108:111], v[112:115], v[12:27]
    buffer_load_dwordx4 v[108:111], v4, s[8:11], s40 offen offset:3072
    buffer_load_dwordx4 v[112:115], v5, s[8:11], s40 offen offset:3072
    s_waitcnt vmcnt(14)
    v_mfma_f32_32x32x16_bf16 v[12:27], v[52:55], v[56:59], v[12:27]
    s_mov_b32 s40, 81920
    buffer_load_dwordx4 v[52:55], v4, s[8:11], s40 offen offset:0
    buffer_load_dwordx4 v[56:59], v5, s[8:11], s40 offen offset:0
    s_waitcnt vmcnt(14)
    v_mfma_f32_32x32x16_bf16 v[12:27], v[60:63], v[64:67], v[12:27]
    buffer_load_dwordx4 v[60:63], v4, s[8:11], s40 offen offset:1024
    buffer_load_dwordx4 v[64:67], v5, s[8:11], s40 offen offset:1024
    s_waitcnt vmcnt(14)
    v_mfma_f32_32x32x16_bf16 v[12:27], v[68:71], v[72:75], v[12:27]
    buffer_load_dwordx4 v[68:71], v4, s[8:11], s40 offen offset:2048
    buffer_load_dwordx4 v[72:75], v5, s[8:11], s40 offen offset:2048
    s_waitcnt vmcnt(14)
    v_mfma_f32_32x32x16_bf16 v[12:27], v[76:79], v[80:83], v[12:27]
    buffer_load_dwordx4 v[76:79], v4, s[8:11], s40 offen offset:3072
    buffer_load_dwordx4 v[80:83], v5, s[8:11], s40 offen offset:3072
    s_waitcnt vmcnt(14)
    v_mfma_f32_32x32x16_bf16 v[12:27], v[84:87], v[88:91], v[12:27]
    s_mov_b32 s40, 86016
    buffer_load_dwordx4 v[84:87], v4, s[8:11], s40 offen offset:0
    buffer_load_dwordx4 v[88:91], v5, s[8:11], s40 offen offset:0
    s_waitcnt vmcnt(14)
    v_mfma_f32_32x32x16_bf16 v[12:27], v[92:95], v[96:99], v[12:27]
    buffer_load_dwordx4 v[92:95], v4, s[8:11], s40 offen offset:1024
    buffer_load_dwordx4 v[96:99], v5, s[8:11], s40 offen offset:1024
    s_waitcnt vmcnt(14)
    v_mfma_f32_32x32x16_bf16 v[12:27], v[100:103], v[104:107], v[12:27]
    s_waitcnt vmcnt(12)
    v_mfma_f32_32x32x16_bf16 v[12:27], v[108:111], v[112:115], v[12:27]
    s_waitcnt vmcnt(10)
    v_mfma_f32_32x32x16_bf16 v[12:27], v[52:55], v[56:59], v[12:27]
    s_waitcnt vmcnt(8)
    v_mfma_f32_32x32x16_bf16 v[12:27], v[60:63], v[64:67], v[12:27]
    s_waitcnt vmcnt(6)
    v_mfma_f32_32x32x16_bf16 v[12:27], v[68:71], v[72:75], v[12:27]
    s_waitcnt vmcnt(4)
    v_mfma_f32_32x32x16_bf16 v[12:27], v[76:79], v[80:83], v[12:27]
    s_waitcnt vmcnt(2)
    v_mfma_f32_32x32x16_bf16 v[12:27], v[84:87], v[88:91], v[12:27]
    s_waitcnt vmcnt(0)
    v_mfma_f32_32x32x16_bf16 v[12:27], v[92:95], v[96:99], v[12:27]
    s_nop 15
    s_nop 7
    v_cvt_pk_bf16_f32 v28, v12, v13
    v_cvt_pk_bf16_f32 v29, v14, v15
    v_cvt_pk_bf16_f32 v30, v16, v17
    v_cvt_pk_bf16_f32 v31, v18, v19
    v_cvt_pk_bf16_f32 v32, v20, v21
    v_cvt_pk_bf16_f32 v33, v22, v23
    v_cvt_pk_bf16_f32 v34, v24, v25
    v_cvt_pk_bf16_f32 v35, v26, v27
    v_lshlrev_b32 v12, 16, v28
    v_and_b32 v13, 0xffff0000, v28
    v_lshlrev_b32 v14, 16, v29
    v_and_b32 v15, 0xffff0000, v29
    v_lshlrev_b32 v16, 16, v30
    v_and_b32 v17, 0xffff0000, v30
    v_lshlrev_b32 v18, 16, v31
    v_and_b32 v19, 0xffff0000, v31
    v_lshlrev_b32 v20, 16, v32
    v_and_b32 v21, 0xffff0000, v32
    v_lshlrev_b32 v22, 16, v33
    v_and_b32 v23, 0xffff0000, v33
    v_lshlrev_b32 v24, 16, v34
    v_and_b32 v25, 0xffff0000, v34
    v_lshlrev_b32 v26, 16, v35
    v_and_b32 v27, 0xffff0000, v35
    v_mul_f32 v12, v12, v6
    v_mul_f32 v13, v13, v6
    v_mul_f32 v14, v14, v6
    v_mul_f32 v15, v15, v6
    v_mul_f32 v16, v16, v6
    v_mul_f32 v17, v17, v6
    v_mul_f32 v18, v18, v6
    v_mul_f32 v19, v19, v6
    v_mul_f32 v20, v20, v6
    v_mul_f32 v21, v21, v6
    v_mul_f32 v22, v22, v6
    v_mul_f32 v23, v23, v6
    v_mul_f32 v24, v24, v6
    v_mul_f32 v25, v25, v6
    v_mul_f32 v26, v26, v6
    v_mul_f32 v27, v27, v6
    v_cvt_pk_bf16_f32 v28, v12, v13
    v_cvt_pk_bf16_f32 v29, v14, v15
    v_cvt_pk_bf16_f32 v30, v16, v17
    v_cvt_pk_bf16_f32 v31, v18, v19
    v_cvt_pk_bf16_f32 v32, v20, v21
    v_cvt_pk_bf16_f32 v33, v22, v23
    v_cvt_pk_bf16_f32 v34, v24, v25
    v_cvt_pk_bf16_f32 v35, v26, v27
    v_lshlrev_b32 v36, 16, v28
    v_and_b32 v37, 0xffff0000, v28
    v_lshlrev_b32 v38, 16, v29
    v_and_b32 v39, 0xffff0000, v29
    v_lshlrev_b32 v40, 16, v30
    v_and_b32 v41, 0xffff0000, v30
    v_lshlrev_b32 v42, 16, v31
    v_and_b32 v43, 0xffff0000, v31
    v_lshlrev_b32 v44, 16, v32
    v_and_b32 v45, 0xffff0000, v32
    v_lshlrev_b32 v46, 16, v33
    v_and_b32 v47, 0xffff0000, v33
    v_lshlrev_b32 v48, 16, v34
    v_and_b32 v49, 0xffff0000, v34
    v_lshlrev_b32 v50, 16, v35
    v_and_b32 v51, 0xffff0000, v35
    s_lshr_b32 s6, s3, 8
    s_lshl_b32 s6, s6, 7
    s_add_u32 s6, s6, 15761408
    v_lshlrev_b32 v4, 2, v2
    s_barrier
    v_lshlrev_b32 v9, 4, v1
    s_lshr_b32 s20, s5, 1
    s_and_b32 s21, s5, 1
    s_lshr_b32 s22, s4, 6
    s_lshl_b32 s22, s22, 1
    s_add_u32 s22, s22, s20
    s_lshl_b32 s22, s22, 15
    s_lshl_b32 s23, s21, 14
    s_add_u32 s22, s22, s23
    s_add_u32 s22, s22, 14680064
    s_lshl_b32 s24, s20, 15
    s_add_u32 s24, s24, s23
    s_add_u32 m0, s24, 0
    s_add_u32 s25, s22, 0
    buffer_load_dwordx4 v9, s[8:11], s25 offen lds
    s_add_u32 m0, s24, 1024
    s_add_u32 s25, s22, 1024
    buffer_load_dwordx4 v9, s[8:11], s25 offen lds
    s_add_u32 m0, s24, 2048
    s_add_u32 s25, s22, 2048
    buffer_load_dwordx4 v9, s[8:11], s25 offen lds
    s_add_u32 m0, s24, 3072
    s_add_u32 s25, s22, 3072
    buffer_load_dwordx4 v9, s[8:11], s25 offen lds
    s_add_u32 m0, s24, 4096
    s_add_u32 s25, s22, 4096
    buffer_load_dwordx4 v9, s[8:11], s25 offen lds
    s_add_u32 m0, s24, 5120
    s_add_u32 s25, s22, 5120
    buffer_load_dwordx4 v9, s[8:11], s25 offen lds
    s_add_u32 m0, s24, 6144
    s_add_u32 s25, s22, 6144
    buffer_load_dwordx4 v9, s[8:11], s25 offen lds
    s_add_u32 m0, s24, 7168
    s_add_u32 s25, s22, 7168
    buffer_load_dwordx4 v9, s[8:11], s25 offen lds
    s_add_u32 m0, s24, 8192
    s_add_u32 s25, s22, 8192
    buffer_load_dwordx4 v9, s[8:11], s25 offen lds
    s_add_u32 m0, s24, 9216
    s_add_u32 s25, s22, 9216
    buffer_load_dwordx4 v9, s[8:11], s25 offen lds
    s_add_u32 m0, s24, 10240
    s_add_u32 s25, s22, 10240
    buffer_load_dwordx4 v9, s[8:11], s25 offen lds
    s_add_u32 m0, s24, 11264
    s_add_u32 s25, s22, 11264
    buffer_load_dwordx4 v9, s[8:11], s25 offen lds
    s_add_u32 m0, s24, 12288
    s_add_u32 s25, s22, 12288
    buffer_load_dwordx4 v9, s[8:11], s25 offen lds
    s_add_u32 m0, s24, 13312
    s_add_u32 s25, s22, 13312
    buffer_load_dwordx4 v9, s[8:11], s25 offen lds
    s_add_u32 m0, s24, 14336
    s_add_u32 s25, s22, 14336
    buffer_load_dwordx4 v9, s[8:11], s25 offen lds
    s_add_u32 m0, s24, 15360
    s_add_u32 s25, s22, 15360
    buffer_load_dwordx4 v9, s[8:11], s25 offen lds
    s_lshr_b32 s22, s3, 6
    s_lshl_b32 s22, s22, 1
    s_add_u32 s22, s22, s20
    s_lshl_b32 s22, s22, 15
    s_add_u32 s22, s22, s23
    s_add_u32 s22, s22, 16777216
    s_add_u32 s24, s24, 65536
    s_mov_b32 s26, 0x400000
K2_POLL:
    buffer_load_dword v5, v4, s[8:11], s6 offen sc1
    s_waitcnt vmcnt(0)
    v_cmp_ne_u32 vcc, 1, v5
    s_nop 4
    s_cmp_eq_u64 vcc, 0
    s_cbranch_scc1 K2_POLLDONE
    s_sleep 2
    s_sub_u32 s26, s26, 1
    s_cmp_lg_u32 s26, 0
    s_cbranch_scc1 K2_POLL
K2_POLLDONE:
    s_add_u32 m0, s24, 0
    s_add_u32 s25, s22, 0
    buffer_load_dwordx4 v9, s[8:11], s25 offen lds
    s_add_u32 m0, s24, 1024
    s_add_u32 s25, s22, 1024
    buffer_load_dwordx4 v9, s[8:11], s25 offen lds
    s_add_u32 m0, s24, 2048
    s_add_u32 s25, s22, 2048
    buffer_load_dwordx4 v9, s[8:11], s25 offen lds
    s_add_u32 m0, s24, 3072
    s_add_u32 s25, s22, 3072
    buffer_load_dwordx4 v9, s[8:11], s25 offen lds
    s_add_u32 m0, s24, 4096
    s_add_u32 s25, s22, 4096
    buffer_load_dwordx4 v9, s[8:11], s25 offen lds
    s_add_u32 m0, s24, 5120
    s_add_u32 s25, s22, 5120
    buffer_load_dwordx4 v9, s[8:11], s25 offen lds
    s_add_u32 m0, s24, 6144
    s_add_u32 s25, s22, 6144
    buffer_load_dwordx4 v9, s[8:11], s25 offen lds
    s_add_u32 m0, s24, 7168
    s_add_u32 s25, s22, 7168
    buffer_load_dwordx4 v9, s[8:11], s25 offen lds
    s_add_u32 m0, s24, 8192
    s_add_u32 s25, s22, 8192
    buffer_load_dwordx4 v9, s[8:11], s25 offen lds
    s_add_u32 m0, s24, 9216
    s_add_u32 s25, s22, 9216
    buffer_load_dwordx4 v9, s[8:11], s25 offen lds
    s_add_u32 m0, s24, 10240
    s_add_u32 s25, s22, 10240
    buffer_load_dwordx4 v9, s[8:11], s25 offen lds
    s_add_u32 m0, s24, 11264
    s_add_u32 s25, s22, 11264
    buffer_load_dwordx4 v9, s[8:11], s25 offen lds
    s_add_u32 m0, s24, 12288
    s_add_u32 s25, s22, 12288
    buffer_load_dwordx4 v9, s[8:11], s25 offen lds
    s_add_u32 m0, s24, 13312
    s_add_u32 s25, s22, 13312
    buffer_load_dwordx4 v9, s[8:11], s25 offen lds
    s_add_u32 m0, s24, 14336
    s_add_u32 s25, s22, 14336
    buffer_load_dwordx4 v9, s[8:11], s25 offen lds
    s_add_u32 m0, s24, 15360
    s_add_u32 s25, s22, 15360
    buffer_load_dwordx4 v9, s[8:11], s25 offen lds
    s_lshl_b32 s6, s20, 15
    v_add_u32 v4, s6, v9
    s_lshl_b32 s6, s21, 15
    s_add_u32 s6, s6, 65536
    v_add_u32 v5, s6, v9
    s_waitcnt vmcnt(0)
    s_barrier
    ds_read_b128 v[52:55], v4 offset:0
    ds_read_b128 v[56:59], v5 offset:0
    ds_read_b128 v[60:63], v4 offset:1024
    ds_read_b128 v[64:67], v5 offset:1024
    ds_read_b128 v[68:71], v4 offset:2048
    ds_read_b128 v[72:75], v5 offset:2048
    ds_read_b128 v[76:79], v4 offset:3072
    ds_read_b128 v[80:83], v5 offset:3072
    s_waitcnt lgkmcnt(6)
    v_mfma_f32_32x32x16_bf16 v[12:27], v[52:55], v[56:59], 0
    ds_read_b128 v[52:55], v4 offset:4096
    ds_read_b128 v[56:59], v5 offset:4096
    s_waitcnt lgkmcnt(6)
    v_mfma_f32_32x32x16_bf16 v[12:27], v[60:63], v[64:67], v[12:27]
    ds_read_b128 v[60:63], v4 offset:5120
    ds_read_b128 v[64:67], v5 offset:5120
    s_waitcnt lgkmcnt(6)
    v_mfma_f32_32x32x16_bf16 v[12:27], v[68:71], v[72:75], v[12:27]
    ds_read_b128 v[68:71], v4 offset:6144
    ds_read_b128 v[72:75], v5 offset:6144
    s_waitcnt lgkmcnt(6)
    v_mfma_f32_32x32x16_bf16 v[12:27], v[76:79], v[80:83], v[12:27]
    ds_read_b128 v[76:79], v4 offset:7168
    ds_read_b128 v[80:83], v5 offset:7168
    s_waitcnt lgkmcnt(6)
    v_mfma_f32_32x32x16_bf16 v[12:27], v[52:55], v[56:59], v[12:27]
    ds_read_b128 v[52:55], v4 offset:8192
    ds_read_b128 v[56:59], v5 offset:8192
    s_waitcnt lgkmcnt(6)
    v_mfma_f32_32x32x16_bf16 v[12:27], v[60:63], v[64:67], v[12:27]
    ds_read_b128 v[60:63], v4 offset:9216
    ds_read_b128 v[64:67], v5 offset:9216
    s_waitcnt lgkmcnt(6)
    v_mfma_f32_32x32x16_bf16 v[12:27], v[68:71], v[72:75], v[12:27]
    ds_read_b128 v[68:71], v4 offset:10240
    ds_read_b128 v[72:75], v5 offset:10240
    s_waitcnt lgkmcnt(6)
    v_mfma_f32_32x32x16_bf16 v[12:27], v[76:79], v[80:83], v[12:27]
    ds_read_b128 v[76:79], v4 offset:11264
    ds_read_b128 v[80:83], v5 offset:11264
    s_waitcnt lgkmcnt(6)
    v_mfma_f32_32x32x16_bf16 v[12:27], v[52:55], v[56:59], v[12:27]
    ds_read_b128 v[52:55], v4 offset:12288
    ds_read_b128 v[56:59], v5 offset:12288
    s_waitcnt lgkmcnt(6)
    v_mfma_f32_32x32x16_bf16 v[12:27], v[60:63], v[64:67], v[12:27]
    ds_read_b128 v[60:63], v4 offset:13312
    ds_read_b128 v[64:67], v5 offset:13312
    s_waitcnt lgkmcnt(6)
    v_mfma_f32_32x32x16_bf16 v[12:27], v[68:71], v[72:75], v[12:27]
    ds_read_b128 v[68:71], v4 offset:14336
    ds_read_b128 v[72:75], v5 offset:14336
    s_waitcnt lgkmcnt(6)
    v_mfma_f32_32x32x16_bf16 v[12:27], v[76:79], v[80:83], v[12:27]
    ds_read_b128 v[76:79], v4 offset:15360
    ds_read_b128 v[80:83], v5 offset:15360
    s_waitcnt lgkmcnt(6)
    v_mfma_f32_32x32x16_bf16 v[12:27], v[52:55], v[56:59], v[12:27]
    ds_read_b128 v[52:55], v4 offset:16384
    ds_read_b128 v[56:59], v5 offset:16384
    s_waitcnt lgkmcnt(6)
    v_mfma_f32_32x32x16_bf16 v[12:27], v[60:63], v[64:67], v[12:27]
    ds_read_b128 v[60:63], v4 offset:17408
    ds_read_b128 v[64:67], v5 offset:17408
    s_waitcnt lgkmcnt(6)
    v_mfma_f32_32x32x16_bf16 v[12:27], v[68:71], v[72:75], v[12:27]
    ds_read_b128 v[68:71], v4 offset:18432
    ds_read_b128 v[72:75], v5 offset:18432
    s_waitcnt lgkmcnt(6)
    v_mfma_f32_32x32x16_bf16 v[12:27], v[76:79], v[80:83], v[12:27]
    ds_read_b128 v[76:79], v4 offset:19456
    ds_read_b128 v[80:83], v5 offset:19456
    s_waitcnt lgkmcnt(6)
    v_mfma_f32_32x32x16_bf16 v[12:27], v[52:55], v[56:59], v[12:27]
    ds_read_b128 v[52:55], v4 offset:20480
    ds_read_b128 v[56:59], v5 offset:20480
    s_waitcnt lgkmcnt(6)
    v_mfma_f32_32x32x16_bf16 v[12:27], v[60:63], v[64:67], v[12:27]
    ds_read_b128 v[60:63], v4 offset:21504
    ds_read_b128 v[64:67], v5 offset:21504
    s_waitcnt lgkmcnt(6)
    v_mfma_f32_32x32x16_bf16 v[12:27], v[68:71], v[72:75], v[12:27]
    ds_read_b128 v[68:71], v4 offset:22528
    ds_read_b128 v[72:75], v5 offset:22528
    s_waitcnt lgkmcnt(6)
    v_mfma_f32_32x32x16_bf16 v[12:27], v[76:79], v[80:83], v[12:27]
    ds_read_b128 v[76:79], v4 offset:23552
    ds_read_b128 v[80:83], v5 offset:23552
    s_waitcnt lgkmcnt(6)
    v_mfma_f32_32x32x16_bf16 v[12:27], v[52:55], v[56:59], v[12:27]
    ds_read_b128 v[52:55], v4 offset:24576
    ds_read_b128 v[56:59], v5 offset:24576
    s_waitcnt lgkmcnt(6)
    v_mfma_f32_32x32x16_bf16 v[12:27], v[60:63], v[64:67], v[12:27]
    ds_read_b128 v[60:63], v4 offset:25600
    ds_read_b128 v[64:67], v5 offset:25600
    s_waitcnt lgkmcnt(6)
    v_mfma_f32_32x32x16_bf16 v[12:27], v[68:71], v[72:75], v[12:27]
    ds_read_b128 v[68:71], v4 offset:26624
    ds_read_b128 v[72:75], v5 offset:26624
    s_waitcnt lgkmcnt(6)
    v_mfma_f32_32x32x16_bf16 v[12:27], v[76:79], v[80:83], v[12:27]
    ds_read_b128 v[76:79], v4 offset:27648
    ds_read_b128 v[80:83], v5 offset:27648
    s_waitcnt lgkmcnt(6)
    v_mfma_f32_32x32x16_bf16 v[12:27], v[52:55], v[56:59], v[12:27]
    ds_read_b128 v[52:55], v4 offset:28672
    ds_read_b128 v[56:59], v5 offset:28672
    s_waitcnt lgkmcnt(6)
    v_mfma_f32_32x32x16_bf16 v[12:27], v[60:63], v[64:67], v[12:27]
    ds_read_b128 v[60:63], v4 offset:29696
    ds_read_b128 v[64:67], v5 offset:29696
    s_waitcnt lgkmcnt(6)
    v_mfma_f32_32x32x16_bf16 v[12:27], v[68:71], v[72:75], v[12:27]
    ds_read_b128 v[68:71], v4 offset:30720
    ds_read_b128 v[72:75], v5 offset:30720
    s_waitcnt lgkmcnt(6)
    v_mfma_f32_32x32x16_bf16 v[12:27], v[76:79], v[80:83], v[12:27]
    ds_read_b128 v[76:79], v4 offset:31744
    ds_read_b128 v[80:83], v5 offset:31744
    s_waitcnt lgkmcnt(6)
    v_mfma_f32_32x32x16_bf16 v[12:27], v[52:55], v[56:59], v[12:27]
    s_waitcnt lgkmcnt(4)
    v_mfma_f32_32x32x16_bf16 v[12:27], v[60:63], v[64:67], v[12:27]
    s_waitcnt lgkmcnt(2)
    v_mfma_f32_32x32x16_bf16 v[12:27], v[68:71], v[72:75], v[12:27]
    s_waitcnt lgkmcnt(0)
    v_mfma_f32_32x32x16_bf16 v[12:27], v[76:79], v[80:83], v[12:27]
    s_nop 15
    s_nop 7
    v_cvt_pk_bf16_f32 v28, v12, v13
    v_cvt_pk_bf16_f32 v29, v14, v15
    v_cvt_pk_bf16_f32 v30, v16, v17
    v_cvt_pk_bf16_f32 v31, v18, v19
    v_cvt_pk_bf16_f32 v32, v20, v21
    v_cvt_pk_bf16_f32 v33, v22, v23
    v_cvt_pk_bf16_f32 v34, v24, v25
    v_cvt_pk_bf16_f32 v35, v26, v27
    v_lshlrev_b32 v12, 16, v28
    v_and_b32 v13, 0xffff0000, v28
    v_lshlrev_b32 v14, 16, v29
    v_and_b32 v15, 0xffff0000, v29
    v_lshlrev_b32 v16, 16, v30
    v_and_b32 v17, 0xffff0000, v30
    v_lshlrev_b32 v18, 16, v31
    v_and_b32 v19, 0xffff0000, v31
    v_lshlrev_b32 v20, 16, v32
    v_and_b32 v21, 0xffff0000, v32
    v_lshlrev_b32 v22, 16, v33
    v_and_b32 v23, 0xffff0000, v33
    v_lshlrev_b32 v24, 16, v34
    v_and_b32 v25, 0xffff0000, v34
    v_lshlrev_b32 v26, 16, v35
    v_and_b32 v27, 0xffff0000, v35
    v_mul_f32 v12, v12, v8
    v_mul_f32 v13, v13, v8
    v_mul_f32 v14, v14, v8
    v_mul_f32 v15, v15, v8
    v_mul_f32 v16, v16, v8
    v_mul_f32 v17, v17, v8
    v_mul_f32 v18, v18, v8
    v_mul_f32 v19, v19, v8
    v_mul_f32 v20, v20, v8
    v_mul_f32 v21, v21, v8
    v_mul_f32 v22, v22, v8
    v_mul_f32 v23, v23, v8
    v_mul_f32 v24, v24, v8
    v_mul_f32 v25, v25, v8
    v_mul_f32 v26, v26, v8
    v_mul_f32 v27, v27, v8
    v_cvt_pk_bf16_f32 v28, v12, v13
    v_cvt_pk_bf16_f32 v29, v14, v15
    v_cvt_pk_bf16_f32 v30, v16, v17
    v_cvt_pk_bf16_f32 v31, v18, v19
    v_cvt_pk_bf16_f32 v32, v20, v21
    v_cvt_pk_bf16_f32 v33, v22, v23
    v_cvt_pk_bf16_f32 v34, v24, v25
    v_cvt_pk_bf16_f32 v35, v26, v27
    v_lshlrev_b32 v12, 16, v28
    v_and_b32 v13, 0xffff0000, v28
    v_lshlrev_b32 v14, 16, v29
    v_and_b32 v15, 0xffff0000, v29
    v_lshlrev_b32 v16, 16, v30
    v_and_b32 v17, 0xffff0000, v30
    v_lshlrev_b32 v18, 16, v31
    v_and_b32 v19, 0xffff0000, v31
    v_lshlrev_b32 v20, 16, v32
    v_and_b32 v21, 0xffff0000, v32
    v_lshlrev_b32 v22, 16, v33
    v_and_b32 v23, 0xffff0000, v33
    v_lshlrev_b32 v24, 16, v34
    v_and_b32 v25, 0xffff0000, v34
    v_lshlrev_b32 v26, 16, v35
    v_and_b32 v27, 0xffff0000, v35
    v_add_f32 v12, v12, v36
    v_add_f32 v13, v13, v37
    v_add_f32 v14, v14, v38
    v_add_f32 v15, v15, v39
    v_add_f32 v16, v16, v40
    v_add_f32 v17, v17, v41
    v_add_f32 v18, v18, v42
    v_add_f32 v19, v19, v43
    v_add_f32 v20, v20, v44
    v_add_f32 v21, v21, v45
    v_add_f32 v22, v22, v46
    v_add_f32 v23, v23, v47
    v_add_f32 v24, v24, v48
    v_add_f32 v25, v25, v49
    v_add_f32 v26, v26, v50
    v_add_f32 v27, v27, v51
    v_cvt_pk_bf16_f32 v28, v12, v13
    v_cvt_pk_bf16_f32 v29, v14, v15
    v_cvt_pk_bf16_f32 v30, v16, v17
    v_cvt_pk_bf16_f32 v31, v18, v19
    v_cvt_pk_bf16_f32 v32, v20, v21
    v_cvt_pk_bf16_f32 v33, v22, v23
    v_cvt_pk_bf16_f32 v34, v24, v25
    v_cvt_pk_bf16_f32 v35, v26, v27
    v_lshlrev_b32 v7, 10, v7
    v_lshl_add_u32 v7, v3, 4, v7
    s_lshl_b32 s7, s4, 1
    v_permlane32_swap_b32 v28, v30
    v_permlane32_swap_b32 v29, v31
    v_permlane32_swap_b32 v32, v34
    v_permlane32_swap_b32 v33, v35
    s_nop 1
    buffer_store_dwordx4 v[28:31], v7, s[44:47], s7 offen nt
    buffer_store_dwordx4 v[32:35], v7, s[44:47], s7 offen offset:32 nt
K2_END:
    s_endpgm
.section .rodata,"a"
.p2align 6
.amdhsa_kernel gm_k1_kernel
  .amdhsa_next_free_vgpr 168
  .amdhsa_next_free_sgpr 102
  .amdhsa_accum_offset 168
  .amdhsa_group_segment_fixed_size 0
  .amdhsa_kernarg_size 88
  .amdhsa_user_sgpr_count 2
  .amdhsa_user_sgpr_kernarg_segment_ptr 1
  .amdhsa_system_sgpr_workgroup_id_x 1
.end_amdhsa_kernel
.p2align 6
.amdhsa_kernel gm_k2_kernel
  .amdhsa_next_free_vgpr 168
  .amdhsa_next_free_sgpr 102
  .amdhsa_accum_offset 168
  .amdhsa_group_segment_fixed_size 0
  .amdhsa_kernarg_size 88
  .amdhsa_user_sgpr_count 2
  .amdhsa_user_sgpr_kernarg_segment_ptr 1
  .amdhsa_system_sgpr_workgroup_id_x 1
.end_amdhsa_kernel
```
